```python
import torch

def _softmax(x, axis=-1):
    return torch.softmax(x, dim=axis)
def _gelu(x):
    return torch.nn.functional.gelu(x, approximate="tanh")
def _silu(x):
    return torch.nn.functional.silu(x)
def _sigmoid(x):
    return torch.sigmoid(x)
def _layernorm(x, axis=-1, eps=1e-5):
    m = x.mean(dim=axis, keepdim=True)
    v = x.var(dim=axis, keepdim=True, unbiased=False)
    return (x - m) / torch.sqrt(v + eps)
def _scatter_add(tgt, idx, src, axis=0):
    return tgt.clone().index_add_(axis, idx, src)
def _segment_sum(src, seg, n):
    out = torch.zeros((n,) + src.shape[1:], dtype=src.dtype)
    return out.index_add_(0, seg, src)
def _pad(x, pw):
    flat = tuple(v for pair in reversed(pw) for v in pair)
    return torch.nn.functional.pad(x, flat)

kernel_name = 'gated_mix__spectral_gfnet__linear_attn_block__prompt'

def setup_inputs():

    _w = (lambda a: (lambda t: t.to(torch.bfloat16) if t.is_floating_point() else t)(torch.as_tensor(a)))
    def _A_setup():
        B, S, D = 1, 2048, 512
        Df = D // 2 + 1
        return {
            "x": _w((lambda *s: torch.randn(*s, dtype=torch.bfloat16) * 0.05)(B, S, D)),
            "w_r": _w((lambda *s: torch.randn(*s, dtype=torch.bfloat16) * 1.6)(S, Df) * 0.02),
            "w_i": _w((lambda *s: torch.randn(*s, dtype=torch.bfloat16) * 1.6)(S, Df) * 0.02),
        }
    _A_in = _A_setup()

    def _B_setup():
        B, S, D = 1, 2048, 512
        return {
            "x": _w((lambda *s: torch.randn(*s, dtype=torch.bfloat16) * 0.05)(B, S, D)),
            "wqkv": _w((lambda *s: torch.randn(*s, dtype=torch.bfloat16) * 0.4)(D, 3 * D)),
            "wo": _w((lambda *s: torch.randn(*s, dtype=torch.bfloat16) * 0.05)(D, D)),
        }
    _B_in = _B_setup()

    return {
        "A_x": _A_in["x"],
        "A_w_r": _A_in["w_r"],
        "A_w_i": _A_in["w_i"],
        "B_x": _B_in["x"],
        "B_wqkv": _B_in["wqkv"],
        "B_wo": _B_in["wo"],
        "gate_w": _w((lambda *s: torch.randn(*s, dtype=torch.bfloat16) * 0.05)(512) * 16.0),
    }

def reference(A_x, A_w_r, A_w_i, B_x, B_wqkv, B_wo, gate_w):
    def _A_ref(x, w_r, w_i):
        B, S, D = x.shape
        X = (lambda x, axes=(-2,-1): torch.fft.rfft2(x.float(), dim=axes))(x, axes=(-2, -1))
        W = w_r + 1j * w_i
        X = X * W
        y = (lambda x, s, axes=(-2,-1): torch.fft.irfft2(x, s=s, dim=axes).to(torch.bfloat16))(X, (S, D), axes=(-2, -1))
        return y

    def _B_ref(x, wqkv, wo):
        B, S, D = x.shape
        H = 32; Dh = D // H
        qkv = (lambda x, *d: x.permute(*d))((x @ wqkv).reshape(B, S, 3, H, Dh), 2, 0, 3, 1, 4)
        q, k, v = qkv[0], qkv[1], qkv[2]
        phi = lambda t: torch.where(t > 0, t + 1, torch.exp(t)) + 1e-6
        pq, pk = phi(q), phi(k)
        kv = torch.einsum("bhsd,bhse->bhde", pk, v)
        z = torch.einsum("bhsd->bhd", pk)
        num = torch.einsum("bhqd,bhde->bhqe", pq, kv)
        den = torch.einsum("bhqd,bhd->bhq", pq, z)[..., None] + 1e-6
        o = num / den
        return (lambda x, *d: x.permute(*d))(o, 0, 2, 1, 3).reshape(B, S, D) @ wo

    x = A_x
    g = _sigmoid((x * gate_w).sum(-1, keepdims=True))
    a = _A_ref(x, A_w_r, A_w_i)
    b = _B_ref(x, B_wqkv, B_wo)
    return g * a + (1 - g) * b
```

```asm
; @launch grid=(256,1,1) block=(512,1,1) lds=163840
.amdgcn_target "amdgcn-amd-amdhsa--gfx950"
.text
.p2align 12
.globl gated_mix__spectral_gfnet__linear_attn_block__prompt_kernel
.p2align 8
.type gated_mix__spectral_gfnet__linear_attn_block__prompt_kernel,@function
gated_mix__spectral_gfnet__linear_attn_block__prompt_kernel:
    s_cmp_ge_u32 s2, 256
    s_cbranch_scc1 L_done
    s_load_dwordx2 s[8:9], s[0:1], 0
    s_load_dwordx2 s[20:21], s[0:1], 32
    s_load_dwordx2 s[12:13], s[0:1], 8
    s_load_dwordx2 s[16:17], s[0:1], 16
    s_load_dwordx2 s[36:37], s[0:1], 72
    s_load_dwordx2 s[28:29], s[0:1], 48
    s_load_dwordx2 s[24:25], s[0:1], 40
    s_load_dwordx2 s[32:33], s[0:1], 56
    s_load_dwordx2 s[100:101], s[0:1], 64
    v_readfirstlane_b32 s46, v0
    v_and_b32 v0, 63, v0
    s_and_b32 s40, s2, 7
    s_lshr_b32 s41, s2, 3
    s_getpc_b64 s[4:5]
    s_lshl_b32 s50, s41, 10
    s_lshl_b32 s51, s46, 1
    s_add_u32 s50, s50, s51
    v_mov_b32 v9, s50
    s_mov_b64 exec, 1
    global_load_dword v9, v9, s[4:5]
    s_mov_b64 exec, -1
    s_lshr_b32 s46, s46, 6
    v_lshlrev_b32 v1, 4, v0
    s_and_b32 s47, s46, 3
    s_lshl_b32 s62, s47, 11
    v_mov_b32 v3, 114688
    v_mov_b32 v4, 0
    v_mov_b32 v5, 0
    v_lshl_add_u32 v2, s46, 2, v3
    ds_write_b32 v2, v4
    ds_write_b64 v3, v[4:5] offset:32
    s_mov_b32 s10, 2097152
    s_mov_b32 s11, 0x20000
    s_lshl_b32 s42, s40, 5
    s_add_u32 s42, s42, s41
    s_cmp_ge_u32 s46, 4
    s_cbranch_scc1 L_G0
    s_mov_b32 s14, 1052672
    s_mov_b32 s15, 0x20000
    s_mov_b32 s18, 1052672
    s_mov_b32 s19, 0x20000
    s_lshl_b32 s50, s40, 17
    s_lshl_b32 s51, s47, 15
    s_add_u32 s50, s50, s51
    s_lshl_b32 s51, s41, 10
    s_add_u32 s50, s50, s51
    s_add_u32 s51, s50, 1047552
    v_lshrrev_b32 v10, 4, v0
    v_mul_u32_u24 v12, 32640, v10
    v_add_u32 v12, v12, v1
    s_and_b32 s52, s42, 63
    s_and_b32 s53, s42, 0xc0
    s_lshl_b32 s53, s53, 2
    s_add_u32 s52, s52, s53
    s_and_b32 s53, s47, 1
    s_lshl_b32 s53, s53, 10
    s_add_u32 s52, s52, s53
    s_mul_i32 s53, s52, 514
    s_and_b32 s54, s47, 2
    s_lshl_b32 s54, s54, 7
    s_add_u32 s53, s53, s54
    v_and_b32 v11, 3, v0
    v_lshl_add_u32 v13, v11, 6, s52
    v_sub_u32 v14, 0x800, v13
    v_and_b32 v14, 0x7ff, v14
    v_and_b32 v15, 8, v0
    v_cmp_eq_u32 vcc, 0, v15
    v_and_b32 v15, 4, v0
    v_lshlrev_b32 v15, 7, v15
    v_cndmask_b32 v13, v14, v13, vcc
    v_mul_u32_u24 v13, 514, v13
    v_add_u32 v16, v13, v15
    s_mov_b32 s30, 1024
    s_mov_b32 s31, 0x20000
    s_lshr_b32 s55, s62, 2
    s_and_b32 s54, s55, 512
    s_add_u32 m0, s62, 117504
    s_waitcnt lgkmcnt(0)
    s_mov_b32 s56, s50
    s_mov_b32 s57, s51
    s_add_u32 s3, s41, s62
    s_cmp_eq_u32 s3, 6148
    s_cbranch_scc1 L_sp5
L_sp5r:
    buffer_load_dwordx4 v1, s[8:11], s56 offen lds
    buffer_load_dwordx4 v1, s[8:11], s57 offen offset:1024 lds
    s_add_u32 m0, s55, 115456
    s_mov_b32 exec_hi, 0
    buffer_load_dwordx4 v1, s[28:31], s54 offen lds
    s_mov_b32 exec_hi, -1
    s_branch L_H1
L_G0:
    s_mov_b32 s22, 1572864
    s_mov_b32 s23, 0x20000
    s_and_b32 s48, s2, 1
    s_and_b32 s49, s41, 3
    s_lshl_b32 s43, s48, 2
    s_add_u32 s43, s43, s49
    s_and_b32 s44, s2, 6
    s_lshl_b32 s44, s44, 7
    s_and_b32 s50, s41, 12
    s_lshl_b32 s50, s50, 4
    s_add_u32 s44, s44, s50
    s_and_b32 s50, s41, 16
    s_lshl_b32 s50, s50, 6
    s_add_u32 s44, s44, s50
    s_lshr_b32 s50, s41, 2
    s_add_u32 s50, s50, s49
    s_and_b32 s50, s50, 1
    s_mul_i32 s50, s50, 4
    s_lshl_b32 s45, s48, 2
    s_add_u32 s45, s45, s40
    s_add_u32 s45, s45, s50
    s_and_b32 s45, s45, 7
    s_lshl_b32 s67, s47, 12
    v_lshrrev_b32 v198, 3, v0
    v_and_b32 v199, 0x70, v1
    v_and_b32 v192, 0x30, v0
    v_xor_b32 v194, v199, v192
    s_lshl_b32 s50, s47, 4
    s_add_u32 s51, s50, s44
    v_add_u32 v195, s51, v198
    v_lshl_add_u32 v194, v195, 10, v194
    v_xor_b32 v195, 64, v194
    v_add_u32 v195, 7168, v195
    v_and_b32 v192, 16, v0
    v_lshlrev_b32 v192, 1, v192
    v_xor_b32 v192, v192, v199
    v_add_u32 v198, s50, v198
    v_mul_u32_u24 v198, 3072, v198
    s_lshl_b32 s51, s43, 7
    v_add3_u32 v192, v192, v198, s51
    v_xor_b32 v198, 64, v192
    v_add_u32 v190, 1024, v192
    v_add_u32 v191, 24576, v198
    v_add_u32 v193, 23552, v198
    s_add_u32 m0, s67, 2048
    s_add_u32 s6, s45, 0
    s_and_b32 s6, s6, 7
    s_lshl_b32 s6, s6, 7
    s_mul_i32 s7, s6, 1536
    s_waitcnt lgkmcnt(0)
    buffer_load_dwordx4 v194, s[8:11], s6 offen lds
    buffer_load_dwordx4 v195, s[8:11], s6 offen offset:1024 lds
    s_add_u32 m0, s67, 0
    s_nop 0
    buffer_load_dwordx4 v190, s[20:23], s7 offen lds
    buffer_load_dwordx4 v191, s[20:23], s7 offen offset:1024 lds
    s_add_u32 m0, s67, 16384
    s_nop 0
    buffer_load_dwordx4 v192, s[20:23], s7 offen offset:2048 lds
    buffer_load_dwordx4 v193, s[20:23], s7 offen offset:3072 lds
    buffer_load_dwordx4 v192, s[20:23], s7 offen lds
    buffer_load_dwordx4 v193, s[20:23], s7 offen offset:1024 lds
    s_branch L_G1
L_H1:
    v_and_b32 v17, 15, v0
    v_cvt_f32_u32 v18, v17
    v_lshlrev_b32 v19, 2, v10
    v_cvt_f32_u32 v19, v19
    v_mul_f32 v43, 0x3d800000, v18
    v_mul_f32 v42, v19, v43
    v_mov_b32 v34, v42
    v_fmamk_f32 v35, v43, 0x3f800000, v42
    v_fmamk_f32 v36, v43, 0x40000000, v42
    v_fmamk_f32 v37, v43, 0x40400000, v42
    v_cos_f32 v26, v34
    v_cos_f32 v27, v35
    v_cos_f32 v28, v36
    v_cos_f32 v29, v37
    v_sin_f32 v34, v34
    v_sin_f32 v35, v35
    v_sin_f32 v36, v36
    v_sin_f32 v37, v37
    v_cvt_pk_bf16_f32 v22, v26, v27
    v_cvt_pk_bf16_f32 v23, v28, v29
    v_cvt_pk_bf16_f32 v24, v34, v35
    v_cvt_pk_bf16_f32 v25, v36, v37
    v_xor_b32 v20, 0x80008000, v24
    v_xor_b32 v21, 0x80008000, v25
    v_mul_f32 v43, 0x3d000000, v18
    v_mul_f32 v42, v19, v43
    v_mov_b32 v34, v42
    v_fmamk_f32 v35, v43, 0x3f800000, v42
    v_fmamk_f32 v36, v43, 0x40000000, v42
    v_fmamk_f32 v37, v43, 0x40400000, v42
    v_cos_f32 v26, v34
    v_cos_f32 v27, v35
    v_cos_f32 v28, v36
    v_cos_f32 v29, v37
    v_sin_f32 v34, v34
    v_sin_f32 v35, v35
    v_sin_f32 v36, v36
    v_sin_f32 v37, v37
    v_cvt_pk_bf16_f32 v46, v26, v27
    v_cvt_pk_bf16_f32 v47, v28, v29
    v_cvt_pk_bf16_f32 v48, v34, v35
    v_cvt_pk_bf16_f32 v49, v36, v37
    v_xor_b32 v44, 0x80008000, v48
    v_xor_b32 v45, 0x80008000, v49
    v_and_b32 v69, 1, v17
    v_sub_u32 v69, 0, v69
    v_and_b32 v69, 0x80008000, v69
    v_xor_b32 v50, v69, v44
    v_xor_b32 v56, 0x80000000, v44
    v_xor_b32 v62, 0x80000000, v50
    v_xor_b32 v51, v69, v45
    v_xor_b32 v57, 0x80000000, v45
    v_xor_b32 v63, 0x80000000, v51
    v_xor_b32 v52, v69, v46
    v_xor_b32 v58, 0x80000000, v46
    v_xor_b32 v64, 0x80000000, v52
    v_xor_b32 v53, v69, v47
    v_xor_b32 v59, 0x80000000, v47
    v_xor_b32 v65, 0x80000000, v53
    v_xor_b32 v54, v69, v48
    v_xor_b32 v60, 0x80000000, v48
    v_xor_b32 v66, 0x80000000, v54
    v_xor_b32 v55, v69, v49
    v_xor_b32 v61, 0x80000000, v49
    v_xor_b32 v67, 0x80000000, v55
    v_mul_f32 v43, 0xbb000000, v18
    v_mul_f32 v42, v19, v43
    v_mov_b32 v34, v42
    v_fmamk_f32 v35, v43, 0x3f800000, v42
    v_fmamk_f32 v36, v43, 0x40000000, v42
    v_fmamk_f32 v37, v43, 0x40400000, v42
    v_cos_f32 v26, v34
    v_cos_f32 v27, v35
    v_cos_f32 v28, v36
    v_cos_f32 v29, v37
    v_sin_f32 v34, v34
    v_sin_f32 v35, v35
    v_sin_f32 v36, v36
    v_sin_f32 v37, v37
    v_fmamk_f32 v38, v43, 0x41800000, v42
    v_fmamk_f32 v39, v43, 0x41880000, v42
    v_fmamk_f32 v40, v43, 0x41900000, v42
    v_fmamk_f32 v41, v43, 0x41980000, v42
    v_cos_f32 v30, v38
    v_cos_f32 v31, v39
    v_cos_f32 v32, v40
    v_cos_f32 v33, v41
    v_sin_f32 v38, v38
    v_sin_f32 v39, v39
    v_sin_f32 v40, v40
    v_sin_f32 v41, v41
    v_lshrrev_b32 v10, 2, v0
    v_lshlrev_b32 v77, 3, v11
    v_lshl_add_u32 v70, v10, 6, v77
    s_add_u32 s50, s62, 117504
    v_add_u32 v70, s50, v70
    v_bfe_u32 v68, v0, 2, 1
    v_lshl_add_u32 v77, v68, 10, v77
    v_bfe_u32 v68, v0, 3, 1
    v_lshl_add_u32 v77, v68, 8, v77
    v_lshrrev_b32 v68, 4, v0
    v_lshl_add_u32 v77, v68, 5, v77
    s_add_u32 s50, s62, 125696
    v_add_u32 v77, s50, v77
    s_and_b32 s50, s47, 1
    s_mul_i32 s51, s50, 1056
    s_add_u32 s51, s51, 135968
    v_mul_u32_u24 v79, 4352, v11
    s_lshl_b32 s52, s50, 2
    s_add_u32 s52, s52, 138048
    v_add_u32 v80, s52, v79
    v_add_u32 v79, s51, v79
    s_and_b32 s52, s47, 2
    s_lshl_b32 s52, s52, 8
    s_add_u32 s51, s51, s52
    v_lshl_add_u32 v78, v0, 2, s51
    v_lshlrev_b32 v68, 4, v68
    v_lshl_add_u32 v71, v17, 6, v68
    s_mul_i32 s50, s47, 4352
    s_add_u32 s50, s50, 133888
    v_add_u32 v71, s50, v71
    s_lshl_b32 s50, s47, 6
    v_add_u32 v10, s50, v10
    v_cmp_eq_u32 vcc, 1, v11
    v_sub_u32 v72, 512, v10
    v_mov_b32 v76, 64
    v_mov_b32 v73, -64
    v_cndmask_b32 v72, v10, v72, vcc
    v_cndmask_b32 v76, v76, v73, vcc
    v_cmp_eq_u32 vcc, 2, v11
    v_add_u32 v73, 520, v10
    v_add_u32 v74, 784, v10
    v_cndmask_b32 v72, v72, v73, vcc
    v_cmp_eq_u32 vcc, 3, v11
    v_mov_b32 v10, 134912
    s_mov_b32 s50, 133888
    v_cndmask_b32 v72, v72, v74, vcc
    v_lshl_add_u32 v72, v72, 2, s50
    v_add_u32 v73, v72, v76
    v_add_u32 v74, v73, v76
    v_add_u32 v75, v74, v76
    v_cmp_eq_u32 vcc, 135936, v72
    v_and_b32 v11, 1, v0
    s_mov_b32 s50, 138048
    v_cndmask_b32 v72, v72, v10, vcc
    v_lshl_add_u32 v76, v11, 2, s50
    s_add_u32 m0, s62, 125696
    s_nop 0
    buffer_load_dwordx4 v12, s[12:15], s53 offen nt lds
    s_add_u32 m0, s62, 126720
    s_nop 0
    buffer_load_dwordx4 v12, s[16:19], s53 offen nt lds
    s_mov_b64 exec, 0xffff
    buffer_load_ushort v13, v16, s[12:15], 0 offen
    buffer_load_ushort v14, v16, s[16:19], 0 offen
    s_mov_b64 exec, -1
    s_and_b32 s48, s2, 1
    s_and_b32 s49, s41, 3
    s_lshl_b32 s43, s48, 2
    s_add_u32 s43, s43, s49
    s_and_b32 s44, s2, 6
    s_lshl_b32 s44, s44, 7
    s_and_b32 s50, s41, 12
    s_lshl_b32 s50, s50, 4
    s_add_u32 s44, s44, s50
    s_and_b32 s50, s41, 16
    s_lshl_b32 s50, s50, 6
    s_add_u32 s44, s44, s50
    s_mov_b32 s38, 9437184
    s_mov_b32 s39, 0x20000
    s_mov_b32 s26, 524288
    s_mov_b32 s27, 0x20000
    s_mov_b32 s34, 2097152
    s_mov_b32 s35, 0x20000
    s_lshr_b32 s64, s44, 5
    s_add_u32 s64, s64, s48
    s_lshr_b32 s65, s46, 2
    s_add_u32 s28, s36, 8978432
    s_addc_u32 s29, s37, 0
    s_mul_i32 s50, s42, 8
    s_lshr_b32 s50, s50, 8
    s_lshl_b32 s50, s50, 11
    s_lshl_b32 s51, s47, 9
    s_add_u32 s50, s50, s51
    s_add_u32 s30, s28, s50
    s_addc_u32 s31, s29, 0
    s_lshr_b32 s50, s41, 2
    s_add_u32 s50, s50, s49
    s_and_b32 s50, s50, 1
    s_mul_i32 s50, s50, 4
    s_lshl_b32 s45, s48, 2
    s_add_u32 s45, s45, s40
    s_add_u32 s45, s45, s50
    s_and_b32 s45, s45, 7
    s_waitcnt lgkmcnt(0)
    s_waitcnt vmcnt(4)
    ds_read_b64_tr_b16 v[82:83], v70 offset:0
    ds_read_b64_tr_b16 v[84:85], v70 offset:1024
    ds_read_b64_tr_b16 v[86:87], v70 offset:32
    ds_read_b64_tr_b16 v[88:89], v70 offset:1056
    s_waitcnt lgkmcnt(2)
    v_mfma_f32_16x16x32_bf16 v[90:93], v[82:85], v[22:25], 0
    v_mfma_f32_16x16x32_bf16 v[98:101], v[82:85], v[20:23], 0
    s_waitcnt lgkmcnt(0)
    v_mfma_f32_16x16x32_bf16 v[94:97], v[86:89], v[22:25], 0
    v_mfma_f32_16x16x32_bf16 v[102:105], v[86:89], v[20:23], 0
    s_nop 3
    v_pk_mul_f32 v[106:107], v[90:91], v[26:27]
    v_pk_mul_f32 v[110:111], v[90:91], v[34:35]
    v_pk_mul_f32 v[108:109], v[92:93], v[28:29]
    v_pk_mul_f32 v[112:113], v[92:93], v[36:37]
    v_pk_fma_f32 v[106:107], v[98:99], v[34:35], v[106:107] neg_lo:[1,0,0] neg_hi:[1,0,0]
    v_pk_fma_f32 v[110:111], v[98:99], v[26:27], v[110:111]
    v_pk_fma_f32 v[108:109], v[100:101], v[36:37], v[108:109] neg_lo:[1,0,0] neg_hi:[1,0,0]
    v_pk_fma_f32 v[112:113], v[100:101], v[28:29], v[112:113]
    v_cvt_pk_bf16_f32 v82, v106, v107
    v_cvt_pk_bf16_f32 v83, v108, v109
    v_cvt_pk_bf16_f32 v84, v110, v111
    v_cvt_pk_bf16_f32 v85, v112, v113
    v_pk_mul_f32 v[106:107], v[94:95], v[30:31]
    v_pk_mul_f32 v[110:111], v[94:95], v[38:39]
    v_pk_mul_f32 v[108:109], v[96:97], v[32:33]
    v_pk_mul_f32 v[112:113], v[96:97], v[40:41]
    v_pk_fma_f32 v[106:107], v[102:103], v[38:39], v[106:107] neg_lo:[1,0,0] neg_hi:[1,0,0]
    v_pk_fma_f32 v[110:111], v[102:103], v[30:31], v[110:111]
    v_pk_fma_f32 v[108:109], v[104:105], v[40:41], v[108:109] neg_lo:[1,0,0] neg_hi:[1,0,0]
    v_pk_fma_f32 v[112:113], v[104:105], v[32:33], v[112:113]
    v_cvt_pk_bf16_f32 v86, v106, v107
    v_cvt_pk_bf16_f32 v87, v108, v109
    v_cvt_pk_bf16_f32 v88, v110, v111
    v_cvt_pk_bf16_f32 v89, v112, v113
    v_mfma_f32_16x16x32_bf16 v[90:93], v[82:85], v[46:49], 0
    v_mfma_f32_16x16x32_bf16 v[98:101], v[82:85], v[44:47], 0
    v_mfma_f32_16x16x32_bf16 v[94:97], v[82:85], v[58:61], 0
    v_mfma_f32_16x16x32_bf16 v[102:105], v[82:85], v[56:59], 0
    v_mfma_f32_16x16x32_bf16 v[90:93], v[86:89], v[52:55], v[90:93]
    v_mfma_f32_16x16x32_bf16 v[98:101], v[86:89], v[50:53], v[98:101]
    v_mfma_f32_16x16x32_bf16 v[94:97], v[86:89], v[64:67], v[94:97]
    v_mfma_f32_16x16x32_bf16 v[102:105], v[86:89], v[62:65], v[102:105]
    s_mov_b64 exec, 1
    s_nop 6
    v_add_f32 v106, v90, v102
    v_sub_f32 v90, v90, v102
    v_sub_f32 v102, v98, v94
    v_add_f32 v98, v98, v94
    v_mov_b32 v94, v106
    s_mov_b64 exec, -1
    v_cvt_pk_bf16_f32 v114, v90, v98
    v_cvt_pk_bf16_f32 v115, v91, v99
    v_cvt_pk_bf16_f32 v116, v92, v100
    v_cvt_pk_bf16_f32 v117, v93, v101
    ds_write_b128 v71, v[114:117] offset:0
    v_cvt_pk_bf16_f32 v118, v94, v102
    v_cvt_pk_bf16_f32 v119, v95, v103
    v_cvt_pk_bf16_f32 v120, v96, v104
    v_cvt_pk_bf16_f32 v121, v97, v105
    ds_write_b128 v71, v[118:121] offset:1024
    s_add_u32 s3, s41, s62
    s_cmp_eq_u32 s3, 6148
    s_cbranch_scc1 L_sp6
L_sp6r:
    s_lshl_b32 s50, s48, 13
    s_and_b32 s51, s47, 2
    s_lshl_b32 s51, s51, 11
    s_add_u32 s50, s50, s51
    s_and_b32 s51, s47, 1
    s_lshl_b32 s51, s51, 10
    s_add_u32 s50, s50, s51
    v_add_u32 v235, s50, v1
    v_lshrrev_b32 v10, 4, v235
    v_xor_b32 v10, v10, v235
    v_and_b32 v10, 0x70, v10
    s_lshl_b32 s50, s45, 7
    s_add_u32 s50, s50, 115456
    v_add_u32 v236, s50, v10
    v_mov_b32 v237, 0
    s_mul_i32 s53, s47, 1064960
    s_lshl_b32 s51, s42, 6
    s_add_u32 s53, s53, s51
    v_lshrrev_b32 v10, 2, v0
    v_and_b32 v11, 3, v0
    v_mul_u32_u24 v21, 16640, v10
    v_lshl_add_u32 v21, v11, 4, v21
    v_lshlrev_b32 v22, 4, v10
    v_and_b32 v10, 1, v11
    v_lshl_add_u32 v22, v10, 8, v22
    v_lshrrev_b32 v10, 1, v11
    v_lshl_add_u32 v22, v10, 13, v22
    s_lshl_b32 s50, s47, 10
    s_add_u32 s51, s50, 117504
    v_add_u32 v22, s51, v22
    s_cmp_eq_u32 s42, 0
    s_mov_b32 s51, 133888
    s_cmov_b32 s51, 125696
    v_add_u32 v238, s51, v1
    v_add_u32 v24, s50, v238
    v_add_u32 v25, 117504, v1
    v_lshrrev_b32 v10, 4, v0
    v_lshlrev_b32 v23, 10, v10
    v_lshl_add_u32 v23, v17, 4, v23
    s_and_b32 s50, s47, 1
    s_lshl_b32 s50, s50, 12
    s_lshr_b32 s51, s47, 1
    s_lshl_b32 s51, s51, 9
    s_add_u32 s50, s50, s51
    s_add_u32 s50, s50, 125696
    v_add_u32 v23, s50, v23
    v_and_b32 v11, 7, v0
    v_xor_b32 v10, v10, v11
    v_lshlrev_b32 v10, 4, v10
    v_lshl_add_u32 v70, v17, 7, v10
    s_add_u32 s50, s62, 117504
    v_add_u32 v70, s50, v70
    v_xor_b32 v71, 64, v70
    v_lshrrev_b32 v10, 3, v0
    v_xor_b32 v81, v11, v10
    v_lshlrev_b32 v81, 4, v81
    v_lshl_add_u32 v81, v10, 7, v81
    v_add_u32 v81, s50, v81
    v_mul_u32_u24 v10, 32768, v10
    s_nop 0
    v_lshl_add_u32 v234, v11, 4, v10
    s_lshl_b32 s50, s47, 4
    v_add_u32 v10, s50, v17
    v_cvt_f32_u32 v12, v10
    v_cvt_f32_u32 v10, s50
    v_add_f32 v10, v10, v19
    v_mul_f32 v43, 0xba000000, v18
    v_mul_f32 v42, v10, v43
    v_mov_b32 v202, v42
    v_fmamk_f32 v203, v43, 0x3f800000, v42
    v_fmamk_f32 v204, v43, 0x40000000, v42
    v_fmamk_f32 v205, v43, 0x40400000, v42
    v_cos_f32 v194, v202
    v_cos_f32 v195, v203
    v_cos_f32 v196, v204
    v_cos_f32 v197, v205
    v_sin_f32 v202, v202
    v_sin_f32 v203, v203
    v_sin_f32 v204, v204
    v_sin_f32 v205, v205
    v_add_f32 v43, 0xbc000000, v43
    v_mul_f32 v42, v10, v43
    s_barrier
    ds_read_b128 v[138:141], v235 offset:2048
    ds_read_b128 v[142:145], v236 offset:0
    v_mov_b32 v206, v42
    v_fmamk_f32 v207, v43, 0x3f800000, v42
    v_fmamk_f32 v208, v43, 0x40000000, v42
    v_fmamk_f32 v209, v43, 0x40400000, v42
    v_cos_f32 v198, v206
    v_cos_f32 v199, v207
    v_cos_f32 v200, v208
    v_cos_f32 v201, v209
    v_sin_f32 v206, v206
    v_sin_f32 v207, v207
    v_sin_f32 v208, v208
    v_sin_f32 v209, v209
    v_mul_f32 v43, 0xbc800000, v12
    v_lshrrev_b32 v10, 5, v0
    v_lshlrev_b32 v10, 2, v10
    v_cvt_f32_u32 v10, v10
    v_bfe_u32 v11, v0, 4, 1
    v_xor_b32 v68, v11, v0
    v_lshlrev_b32 v68, 31, v68
    v_xor_b32 v42, 0xbe000000, v68
    v_lshlrev_b32 v68, 31, v11
    v_fmac_f32 v42, v10, v43
    s_mov_b32 s58, 0x3f3504f3
    s_mov_b32 s59, 0x3f3504f3
    v_mov_b32 v94, v42
    v_fmamk_f32 v95, v43, 0x3f800000, v42
    v_fmamk_f32 v96, v43, 0x40000000, v42
    v_fmamk_f32 v97, v43, 0x40400000, v42
    v_cos_f32 v90, v94
    v_cos_f32 v91, v95
    v_cos_f32 v92, v96
    v_cos_f32 v93, v97
    v_sin_f32 v94, v94
    v_sin_f32 v95, v95
    v_sin_f32 v96, v96
    v_sin_f32 v97, v97
    v_cvt_pk_bf16_f32 v162, v90, -v94
    v_cvt_pk_bf16_f32 v166, v94, v90
    v_cvt_pk_bf16_f32 v163, v91, -v95
    v_cvt_pk_bf16_f32 v167, v95, v91
    s_waitcnt vmcnt(0)
    ds_read_b64_tr_b16 v[130:131], v77 offset:0
    ds_read_b64_tr_b16 v[132:133], v77 offset:512
    ds_read_b64_tr_b16 v[134:135], v77 offset:128
    ds_read_b64_tr_b16 v[136:137], v77 offset:640
    v_lshlrev_b32 v13, 16, v13
    v_lshlrev_b32 v14, 16, v14
    v_mul_f32 v13, 0x3e800000, v13
    v_mul_f32 v14, 0x3e800000, v14
    s_nop 0
    v_add_f32_dpp v15, v13, v13 row_ror:8 row_mask:0xf bank_mask:0xf
    v_subrev_f32_dpp v16, v14, v14 row_ror:8 row_mask:0xf bank_mask:0xf
    s_nop 0
    v_add_f32_dpp v13, v15, v15 row_ror:12 row_mask:0xf bank_mask:0xf
    v_add_f32_dpp v14, v16, v16 row_ror:12 row_mask:0xf bank_mask:0xf
    v_subrev_f32_dpp v106, v15, v15 row_ror:12 row_mask:0xf bank_mask:0xf
    v_subrev_f32_dpp v107, v16, v16 row_ror:12 row_mask:0xf bank_mask:0xf
    v_cvt_pk_bf16_f32 v13, v13, v14
    v_cvt_pk_bf16_f32 v14, v106, v107
    s_waitcnt lgkmcnt(0)
    ds_write2st64_b32 v78, v130, v134 offset0:0 offset1:1
    ds_write2st64_b32 v78, v131, v135 offset0:17 offset1:18
    ds_write2st64_b32 v78, v132, v136 offset0:34 offset1:35
    ds_write2st64_b32 v78, v133, v137 offset0:51 offset1:52
    s_mov_b64 exec, 15
    ds_write_b32 v79, v13
    ds_write_b32 v80, v14
    s_mov_b64 exec, -1
    s_waitcnt lgkmcnt(0)
    v_dot2_f32_bf16 v237, v138, v142, v237
    v_dot2_f32_bf16 v237, v139, v143, v237
    v_dot2_f32_bf16 v237, v140, v144, v237
    v_dot2_f32_bf16 v237, v141, v145, v237
    s_barrier
    ds_read2st64_b32 v[114:115], v72 offset0:0 offset1:17
    ds_read2st64_b32 v[116:117], v72 offset0:34 offset1:51
    ds_read2st64_b32 v[118:119], v73 offset0:0 offset1:17
    ds_read2st64_b32 v[120:121], v73 offset0:34 offset1:51
    ds_read2st64_b32 v[122:123], v74 offset0:0 offset1:17
    ds_read2st64_b32 v[124:125], v74 offset0:34 offset1:51
    ds_read2st64_b32 v[126:127], v75 offset0:0 offset1:17
    ds_read2st64_b32 v[128:129], v75 offset0:34 offset1:51
    ds_read2st64_b32 v[130:131], v76 offset0:0 offset1:17
    ds_read2st64_b32 v[132:133], v76 offset0:34 offset1:51
    s_mul_i32 s50, s42, 16640
    s_lshl_b32 s51, s47, 12
    s_add_u32 s51, s50, s51
    s_waitcnt lgkmcnt(8)
    buffer_store_dwordx4 v[114:117], v1, s[36:39], s51 offen offset:0 sc1
    s_waitcnt lgkmcnt(6)
    buffer_store_dwordx4 v[118:121], v1, s[36:39], s51 offen offset:1024 sc1
    s_waitcnt lgkmcnt(4)
    buffer_store_dwordx4 v[122:125], v1, s[36:39], s51 offen offset:2048 sc1
    s_waitcnt lgkmcnt(2)
    buffer_store_dwordx4 v[126:129], v1, s[36:39], s51 offen offset:3072 sc1
    s_cmp_lg_u32 s47, 0
    s_cbranch_scc1 x_1
    s_and_b32 s50, s42, 0x30
    s_lshl_b32 s50, s50, 7
    s_and_b32 s51, s42, 15
    s_lshl_b32 s51, s51, 4
    s_add_u32 s50, s50, s51
    s_and_b32 s51, s42, 0xc0
    s_lshl_b32 s51, s51, 2
    s_add_u32 s50, s50, s51
    s_add_u32 s50, s50, 9109504
    v_lshlrev_b32 v106, 10, v0
    s_waitcnt lgkmcnt(0)
    s_mov_b64 exec, 3
    buffer_store_dwordx4 v[130:133], v106, s[36:39], s50 offen sc1
    s_mov_b64 exec, -1
    s_cmp_ge_u32 s42, 64
    s_cbranch_scc1 x_1
    v_mov_b32 v106, 0
    v_mov_b32 v107, 0
    v_mov_b32 v108, 0
    v_mov_b32 v109, 0
    s_lshl_b32 s50, s42, 10
    s_add_u32 s50, s50, 8912896
    buffer_store_dwordx4 v[106:109], v1, s[36:39], s50 offen sc1
    s_nop 1
x_1:
    ds_read_b128 v[138:141], v235 offset:34816
    ds_read_b128 v[142:145], v236 offset:128
    v_cvt_pk_bf16_f32 v164, v92, -v96
    v_cvt_pk_bf16_f32 v168, v96, v92
    v_cvt_pk_bf16_f32 v165, v93, -v97
    v_cvt_pk_bf16_f32 v169, v97, v93
    v_xor_b32 v162, v68, v162
    v_xor_b32 v163, v68, v163
    v_xor_b32 v164, v68, v164
    v_xor_b32 v165, v68, v165
    v_xor_b32 v166, v68, v166
    v_xor_b32 v167, v68, v167
    v_xor_b32 v168, v68, v168
    v_xor_b32 v169, v68, v169
    v_fmamk_f32 v94, v43, 0x41000000, v42
    v_fmamk_f32 v95, v43, 0x41100000, v42
    v_fmamk_f32 v96, v43, 0x41200000, v42
    v_fmamk_f32 v97, v43, 0x41300000, v42
    v_cos_f32 v90, v94
    v_cos_f32 v91, v95
    v_cos_f32 v92, v96
    v_cos_f32 v93, v97
    s_waitcnt lgkmcnt(0)
    s_cmp_lg_u32 s47, 0
    s_cbranch_scc1 w_2
    s_load_dword s63, s[100:101], 0
w_2:
    v_dot2_f32_bf16 v237, v138, v142, v237
    v_dot2_f32_bf16 v237, v139, v143, v237
    v_dot2_f32_bf16 v237, v140, v144, v237
    v_dot2_f32_bf16 v237, v141, v145, v237
    s_barrier
    v_add_u32 v138, 67584, v235
    ds_read_b128 v[138:141], v138
    ds_read_b128 v[142:145], v236 offset:256
    v_sin_f32 v94, v94
    v_sin_f32 v95, v95
    v_sin_f32 v96, v96
    v_sin_f32 v97, v97
    v_cvt_pk_bf16_f32 v170, v90, -v94
    v_cvt_pk_bf16_f32 v174, v94, v90
    v_cvt_pk_bf16_f32 v171, v91, -v95
    v_cvt_pk_bf16_f32 v175, v95, v91
    v_cvt_pk_bf16_f32 v172, v92, -v96
    v_cvt_pk_bf16_f32 v176, v96, v92
    s_waitcnt lgkmcnt(0)
    s_cmp_lg_u32 s47, 0
    s_cbranch_scc1 r_4
    s_mov_b32 s66, 0x2000
r_3:
    s_cmp_ge_u32 s63, 8
    s_cbranch_scc1 r_4
    s_sleep 4
    v_mov_b32 v4, 0
    global_load_dword v4, v4, s[100:101] sc1
    s_waitcnt vmcnt(0)
    v_readfirstlane_b32 s63, v4
    s_sub_u32 s66, s66, 1
    s_cbranch_scc0 r_3
r_4:
    v_dot2_f32_bf16 v237, v138, v142, v237
    v_dot2_f32_bf16 v237, v139, v143, v237
    v_dot2_f32_bf16 v237, v140, v144, v237
    v_dot2_f32_bf16 v237, v141, v145, v237
    v_cvt_pk_bf16_f32 v173, v93, -v97
    v_cvt_pk_bf16_f32 v177, v97, v93
    v_xor_b32 v170, v68, v170
    v_xor_b32 v171, v68, v171
    v_xor_b32 v172, v68, v172
    v_xor_b32 v173, v68, v173
    v_xor_b32 v174, v68, v174
    v_xor_b32 v175, v68, v175
    v_xor_b32 v176, v68, v176
    v_xor_b32 v177, v68, v177
    s_mov_b32 s4, 0xaaaaaaaa
    s_mov_b32 s5, 0xaaaaaaaa
    v_bfe_i32 v20, v0, 1, 1
    v_and_b32 v20, 0x80008000, v20
    v_xor_b32 v68, v20, v69
    v_cndmask_b32 v178, v162, v166, s[4:5]
    v_cndmask_b32 v182, v166, v162, s[4:5]
    v_xor_b32 v178, v20, v178
    v_xor_b32 v182, v68, v182
    v_cndmask_b32 v179, v163, v167, s[4:5]
    v_cndmask_b32 v183, v167, v163, s[4:5]
    v_xor_b32 v179, v20, v179
    s_waitcnt vmcnt(0)
    s_barrier
    v_add_u32 v138, 100352, v235
    ds_read_b128 v[138:141], v138
    ds_read_b128 v[142:145], v236 offset:384
    s_waitcnt lgkmcnt(0)
    s_lshl_b32 s56, s40, 8
    s_add_u32 s56, s56, s62
    s_add_u32 s56, s28, s56
    s_addc_u32 s57, s29, 0
    s_mov_b32 s3, 1
    s_atomic_add s3, s[56:57], 0
    s_atomic_add s3, s[56:57], 8192
    v_dot2_f32_bf16 v237, v138, v142, v237
    v_dot2_f32_bf16 v237, v139, v143, v237
    v_dot2_f32_bf16 v237, v140, v144, v237
    v_dot2_f32_bf16 v237, v141, v145, v237
    v_xor_b32 v183, v68, v183
    v_cndmask_b32 v180, v164, v168, s[4:5]
    v_cndmask_b32 v184, v168, v164, s[4:5]
    v_xor_b32 v180, v20, v180
    v_xor_b32 v184, v68, v184
    v_cndmask_b32 v181, v165, v169, s[4:5]
    v_cndmask_b32 v185, v169, v165, s[4:5]
    v_xor_b32 v181, v20, v181
    v_xor_b32 v185, v68, v185
    v_cndmask_b32 v186, v170, v174, s[4:5]
    v_cndmask_b32 v190, v174, v170, s[4:5]
    v_xor_b32 v186, v20, v186
    v_xor_b32 v190, v68, v190
    v_cndmask_b32 v187, v171, v175, s[4:5]
    v_cndmask_b32 v191, v175, v171, s[4:5]
    v_xor_b32 v187, v20, v187
    v_xor_b32 v191, v68, v191
    v_cndmask_b32 v188, v172, v176, s[4:5]
    v_cndmask_b32 v192, v176, v172, s[4:5]
    v_xor_b32 v188, v20, v188
    v_xor_b32 v192, v68, v192
    v_cndmask_b32 v189, v173, v177, s[4:5]
    v_cndmask_b32 v193, v177, v173, s[4:5]
    v_xor_b32 v189, v20, v189
    v_xor_b32 v193, v68, v193
    v_mul_f32 v43, 0xba000000, v12
    v_mul_f32 v42, v19, v43
    v_mov_b32 v34, v42
    v_fmamk_f32 v35, v43, 0x3f800000, v42
    v_fmamk_f32 v36, v43, 0x40000000, v42
    v_fmamk_f32 v37, v43, 0x40400000, v42
    v_cos_f32 v26, v34
    s_barrier
    ds_read_b128 v[138:141], v235 offset:18432
    ds_read_b128 v[142:145], v236 offset:512
    v_cos_f32 v27, v35
    v_cos_f32 v28, v36
    v_cos_f32 v29, v37
    v_sin_f32 v34, v34
    v_sin_f32 v35, v35
    v_sin_f32 v36, v36
    v_sin_f32 v37, v37
    v_fmamk_f32 v38, v43, 0x41800000, v42
    v_fmamk_f32 v39, v43, 0x41880000, v42
    v_fmamk_f32 v40, v43, 0x41900000, v42
    s_waitcnt lgkmcnt(0)
    v_dot2_f32_bf16 v237, v138, v142, v237
    v_dot2_f32_bf16 v237, v139, v143, v237
    v_dot2_f32_bf16 v237, v140, v144, v237
    v_dot2_f32_bf16 v237, v141, v145, v237
    v_fmamk_f32 v41, v43, 0x41980000, v42
    v_cos_f32 v30, v38
    v_cos_f32 v31, v39
    v_cos_f32 v32, v40
    v_cos_f32 v33, v41
    v_sin_f32 v38, v38
    v_sin_f32 v39, v39
    v_sin_f32 v40, v40
    v_sin_f32 v41, v41
    v_pk_mul_f32 v[26:27], v[26:27], s[58:59]
    v_pk_mul_f32 v[34:35], v[34:35], s[58:59]
    v_pk_mul_f32 v[28:29], v[28:29], s[58:59]
    v_pk_mul_f32 v[36:37], v[36:37], s[58:59]
    v_pk_mul_f32 v[30:31], v[30:31], s[58:59]
    v_pk_mul_f32 v[38:39], v[38:39], s[58:59]
    v_pk_mul_f32 v[32:33], v[32:33], s[58:59]
    v_pk_mul_f32 v[40:41], v[40:41], s[58:59]
    v_mul_f32 v43, 0x3c800000, v12
    v_mul_f32 v42, v19, v43
    v_mov_b32 v94, v42
    v_fmamk_f32 v95, v43, 0x3f800000, v42
    v_fmamk_f32 v96, v43, 0x40000000, v42
    s_barrier
    ds_read_b128 v[138:141], v235 offset:51200
    ds_read_b128 v[142:145], v236 offset:640
    v_fmamk_f32 v97, v43, 0x40400000, v42
    v_cos_f32 v90, v94
    v_cos_f32 v91, v95
    v_cos_f32 v92, v96
    v_cos_f32 v93, v97
    v_sin_f32 v94, v94
    v_sin_f32 v95, v95
    v_sin_f32 v96, v96
    v_sin_f32 v97, v97
    v_cvt_pk_bf16_f32 v212, v90, v91
    s_waitcnt lgkmcnt(0)
    s_mov_b32 s63, 0
    s_atomic_add s63, s[30:31], 0 glc
    s_mov_b32 s52, 0
    s_atomic_add s52, s[30:31], 256 glc
    s_cmp_eq_u32 s42, 0
    s_cbranch_scc1 L_sp4
L_sp4r:
    v_dot2_f32_bf16 v237, v138, v142, v237
    v_dot2_f32_bf16 v237, v139, v143, v237
    v_dot2_f32_bf16 v237, v140, v144, v237
    v_dot2_f32_bf16 v237, v141, v145, v237
    v_cvt_pk_bf16_f32 v213, v92, v93
    v_cvt_pk_bf16_f32 v214, v94, v95
    v_cvt_pk_bf16_f32 v215, v96, v97
    v_xor_b32 v210, 0x80008000, v214
    v_xor_b32 v211, 0x80008000, v215
    v_fmamk_f32 v94, v43, 0x41800000, v42
    v_fmamk_f32 v95, v43, 0x41880000, v42
    v_fmamk_f32 v96, v43, 0x41900000, v42
    v_fmamk_f32 v97, v43, 0x41980000, v42
    v_cos_f32 v90, v94
    v_cos_f32 v91, v95
    v_cos_f32 v92, v96
    v_cos_f32 v93, v97
    v_sin_f32 v94, v94
    v_sin_f32 v95, v95
    v_sin_f32 v96, v96
    v_sin_f32 v97, v97
    v_cvt_pk_bf16_f32 v218, v90, v91
    v_cvt_pk_bf16_f32 v219, v92, v93
    v_cvt_pk_bf16_f32 v220, v94, v95
    v_cvt_pk_bf16_f32 v221, v96, v97
    v_xor_b32 v216, 0x80008000, v220
    s_barrier
    v_add_u32 v138, 83968, v235
    ds_read_b128 v[138:141], v138
    ds_read_b128 v[142:145], v236 offset:768
    s_waitcnt lgkmcnt(0)
    s_mov_b32 s66, 0x2000
    s_and_b32 s63, s63, s52
    s_cmp_lg_u32 s63, 32
    s_cbranch_scc1 late_5
    s_cmp_lg_u32 s42, 0
    s_cbranch_scc1 m_6
    s_getpc_b64 s[6:7]
    s_branch L_sp3
m_6:
    buffer_load_dwordx4 v[114:117], v21, s[36:39], s53 offen sc1
    s_add_u32 s53, s53, 266240
    buffer_load_dwordx4 v[118:121], v21, s[36:39], s53 offen sc1
    s_add_u32 s53, s53, 266240
    buffer_load_dwordx4 v[122:125], v21, s[36:39], s53 offen sc1
    s_add_u32 s53, s53, 266240
    buffer_load_dwordx4 v[126:129], v21, s[36:39], s53 offen sc1
    v_mov_b32 v8, 3
    ds_write_b32 v2, v8
    s_mov_b32 s66, 0
late_5:
    v_dot2_f32_bf16 v237, v138, v142, v237
    v_dot2_f32_bf16 v237, v139, v143, v237
    v_dot2_f32_bf16 v237, v140, v144, v237
    v_dot2_f32_bf16 v237, v141, v145, v237
    v_xor_b32 v217, 0x80008000, v221
    v_xor_b32 v222, v69, v210
    v_xor_b32 v223, v69, v211
    v_xor_b32 v224, v69, v212
    v_xor_b32 v225, v69, v213
    v_xor_b32 v226, v69, v214
    v_xor_b32 v227, v69, v215
    v_xor_b32 v228, v69, v216
    v_xor_b32 v229, v69, v217
    v_xor_b32 v230, v69, v218
    v_xor_b32 v231, v69, v219
    v_xor_b32 v232, v69, v220
    v_xor_b32 v233, v69, v221
    s_barrier
    ds_read_b128 v[138:141], v235 offset:2048
    ds_read_b128 v[142:145], v236 offset:896
    s_barrier
    s_cmp_eq_u32 s66, 0
    s_cbranch_scc1 ok_9
p_7:
    s_sub_u32 s66, s66, 1
    s_cbranch_scc1 q_8
    s_mov_b32 s63, 0
    s_atomic_add s63, s[30:31], 0 glc
    s_mov_b32 s52, 0
    s_atomic_add s52, s[30:31], 256 glc
    s_waitcnt lgkmcnt(0)
    s_and_b32 s63, s63, s52
    s_cmp_lg_u32 s63, 32
    s_cbranch_scc1 p_7
q_8:
    s_cmp_lg_u32 s42, 0
    s_cbranch_scc1 m_10
    s_getpc_b64 s[6:7]
    s_branch L_sp3
m_10:
    buffer_load_dwordx4 v[114:117], v21, s[36:39], s53 offen sc1
    s_add_u32 s53, s53, 266240
    buffer_load_dwordx4 v[118:121], v21, s[36:39], s53 offen sc1
    s_add_u32 s53, s53, 266240
    buffer_load_dwordx4 v[122:125], v21, s[36:39], s53 offen sc1
    s_add_u32 s53, s53, 266240
    buffer_load_dwordx4 v[126:129], v21, s[36:39], s53 offen sc1
    v_mov_b32 v8, 3
    ds_write_b32 v2, v8
ok_9:
    s_waitcnt lgkmcnt(0)
    v_dot2_f32_bf16 v237, v138, v142, v237
    v_dot2_f32_bf16 v237, v139, v143, v237
    v_dot2_f32_bf16 v237, v140, v144, v237
    v_dot2_f32_bf16 v237, v141, v145, v237
    s_waitcnt vmcnt(3)
    ds_write_b128 v22, v[114:117] offset:0
    s_waitcnt vmcnt(2)
    ds_write_b128 v22, v[118:121] offset:4096
    s_waitcnt vmcnt(1)
    ds_write_b128 v22, v[122:125] offset:512
    s_waitcnt vmcnt(0)
    ds_write_b128 v22, v[126:129] offset:4608
    v_mov_b32 v8, 4
    ds_write_b32 v2, v8
    ds_read_b128 v[4:7], v3 offset:0
sw_11:
    s_waitcnt lgkmcnt(0)
    v_min3_u32 v4, v4, v5, v6
    v_min_u32 v4, v4, v7
    s_nop 0
    v_readfirstlane_b32 s57, v4
    s_nop 1
    s_cmp_ge_u32 s57, 4
    s_cbranch_scc1 sd_12
    ds_read_b128 v[4:7], v3 offset:0
    s_branch sw_11
sd_12:
    ds_read_b128 v[114:117], v25 offset:0
    ds_read_b128 v[118:121], v25 offset:1024
    ds_read_b128 v[122:125], v25 offset:2048
    ds_read_b128 v[126:129], v25 offset:3072
    ds_read_b128 v[130:133], v25 offset:4096
    ds_read_b128 v[134:137], v25 offset:5120
    ds_read_b128 v[138:141], v25 offset:6144
    ds_read_b128 v[142:145], v25 offset:7168
    ds_read_b128 v[240:243], v23 offset:0
    ds_read_b128 v[244:247], v23 offset:256
    s_waitcnt lgkmcnt(9)
    v_mfma_f32_16x16x32_bf16 v[90:93], v[114:117], v[162:165], 0
    v_mfma_f32_16x16x32_bf16 v[98:101], v[114:117], v[166:169], 0
    s_waitcnt lgkmcnt(8)
    v_mfma_f32_16x16x32_bf16 v[90:93], v[118:121], v[170:173], v[90:93]
    v_mfma_f32_16x16x32_bf16 v[98:101], v[118:121], v[174:177], v[98:101]
    s_waitcnt lgkmcnt(7)
    v_mfma_f32_16x16x32_bf16 v[90:93], v[122:125], v[178:181], v[90:93]
    v_mfma_f32_16x16x32_bf16 v[98:101], v[122:125], v[182:185], v[98:101]
    s_waitcnt lgkmcnt(6)
    v_mfma_f32_16x16x32_bf16 v[90:93], v[126:129], v[186:189], v[90:93]
    v_mfma_f32_16x16x32_bf16 v[98:101], v[126:129], v[190:193], v[98:101]
    s_waitcnt lgkmcnt(5)
    v_mfma_f32_16x16x32_bf16 v[94:97], v[130:133], v[162:165], 0
    v_mfma_f32_16x16x32_bf16 v[102:105], v[130:133], v[166:169], 0
    s_waitcnt lgkmcnt(4)
    v_mfma_f32_16x16x32_bf16 v[94:97], v[134:137], v[170:173], v[94:97]
    v_mfma_f32_16x16x32_bf16 v[102:105], v[134:137], v[174:177], v[102:105]
    s_waitcnt lgkmcnt(3)
    v_mfma_f32_16x16x32_bf16 v[94:97], v[138:141], v[178:181], v[94:97]
    v_mfma_f32_16x16x32_bf16 v[102:105], v[138:141], v[182:185], v[102:105]
    s_waitcnt lgkmcnt(2)
    v_mfma_f32_16x16x32_bf16 v[94:97], v[142:145], v[186:189], v[94:97]
    v_mfma_f32_16x16x32_bf16 v[102:105], v[142:145], v[190:193], v[102:105]
    v_pk_mul_f32 v[106:107], v[90:91], v[26:27]
    v_pk_mul_f32 v[110:111], v[90:91], v[34:35]
    v_pk_mul_f32 v[108:109], v[92:93], v[28:29]
    v_pk_mul_f32 v[112:113], v[92:93], v[36:37]
    v_pk_fma_f32 v[106:107], v[98:99], v[34:35], v[106:107] neg_lo:[1,0,0] neg_hi:[1,0,0]
    v_pk_fma_f32 v[110:111], v[98:99], v[26:27], v[110:111]
    v_pk_fma_f32 v[108:109], v[100:101], v[36:37], v[108:109] neg_lo:[1,0,0] neg_hi:[1,0,0]
    v_pk_fma_f32 v[112:113], v[100:101], v[28:29], v[112:113]
    v_cvt_pk_bf16_f32 v82, v106, v107
    v_cvt_pk_bf16_f32 v83, v108, v109
    v_cvt_pk_bf16_f32 v84, v110, v111
    v_cvt_pk_bf16_f32 v85, v112, v113
    v_pk_mul_f32 v[106:107], v[94:95], v[30:31]
    v_pk_mul_f32 v[110:111], v[94:95], v[38:39]
    v_pk_mul_f32 v[108:109], v[96:97], v[32:33]
    v_pk_mul_f32 v[112:113], v[96:97], v[40:41]
    v_pk_fma_f32 v[106:107], v[102:103], v[38:39], v[106:107] neg_lo:[1,0,0] neg_hi:[1,0,0]
    v_pk_fma_f32 v[110:111], v[102:103], v[30:31], v[110:111]
    v_pk_fma_f32 v[108:109], v[104:105], v[40:41], v[108:109] neg_lo:[1,0,0] neg_hi:[1,0,0]
    v_pk_fma_f32 v[112:113], v[104:105], v[32:33], v[112:113]
    v_cvt_pk_bf16_f32 v86, v106, v107
    v_cvt_pk_bf16_f32 v87, v108, v109
    v_cvt_pk_bf16_f32 v88, v110, v111
    v_cvt_pk_bf16_f32 v89, v112, v113
    v_mfma_f32_16x16x32_bf16 v[90:93], v[46:49], v[82:85], 0
    v_mfma_f32_16x16x32_bf16 v[98:101], v[44:47], v[82:85], 0
    v_mfma_f32_16x16x32_bf16 v[94:97], v[58:61], v[82:85], 0
    v_mfma_f32_16x16x32_bf16 v[102:105], v[56:59], v[82:85], 0
    v_mfma_f32_16x16x32_bf16 v[90:93], v[52:55], v[86:89], v[90:93]
    v_mfma_f32_16x16x32_bf16 v[98:101], v[50:53], v[86:89], v[98:101]
    v_mfma_f32_16x16x32_bf16 v[94:97], v[64:67], v[86:89], v[94:97]
    v_mfma_f32_16x16x32_bf16 v[102:105], v[62:65], v[86:89], v[102:105]
    s_waitcnt lgkmcnt(0)
    s_cmp_eq_u32 s42, 0
    s_cbranch_scc1 L_sp2
    v_lshlrev_b32 v146, 16, v240
    v_and_b32 v154, 0xffff0000, v240
    v_lshlrev_b32 v147, 16, v241
    v_and_b32 v155, 0xffff0000, v241
    v_lshlrev_b32 v148, 16, v242
    v_and_b32 v156, 0xffff0000, v242
    v_lshlrev_b32 v149, 16, v243
    v_and_b32 v157, 0xffff0000, v243
    v_lshlrev_b32 v150, 16, v244
    v_and_b32 v158, 0xffff0000, v244
    v_lshlrev_b32 v151, 16, v245
    v_and_b32 v159, 0xffff0000, v245
    v_lshlrev_b32 v152, 16, v246
    v_and_b32 v160, 0xffff0000, v246
    v_lshlrev_b32 v153, 16, v247
    v_and_b32 v161, 0xffff0000, v247
    v_pk_mul_f32 v[106:107], v[90:91], v[146:147]
    v_pk_mul_f32 v[110:111], v[90:91], v[154:155]
    v_pk_mul_f32 v[108:109], v[92:93], v[148:149]
    v_pk_mul_f32 v[112:113], v[92:93], v[156:157]
    v_pk_fma_f32 v[106:107], v[98:99], v[154:155], v[106:107] neg_lo:[1,0,0] neg_hi:[1,0,0]
    v_pk_fma_f32 v[110:111], v[98:99], v[146:147], v[110:111]
    v_pk_fma_f32 v[108:109], v[100:101], v[156:157], v[108:109] neg_lo:[1,0,0] neg_hi:[1,0,0]
    v_pk_fma_f32 v[112:113], v[100:101], v[148:149], v[112:113]
    v_cvt_pk_bf16_f32 v82, v106, v107
    v_cvt_pk_bf16_f32 v83, v108, v109
    v_cvt_pk_bf16_f32 v84, -v110, -v111
    v_cvt_pk_bf16_f32 v85, -v112, -v113
    v_pk_mul_f32 v[106:107], v[94:95], v[150:151]
    v_pk_mul_f32 v[110:111], v[94:95], v[158:159]
    v_pk_mul_f32 v[108:109], v[96:97], v[152:153]
    v_pk_mul_f32 v[112:113], v[96:97], v[160:161]
    v_pk_fma_f32 v[106:107], v[102:103], v[158:159], v[106:107] neg_lo:[1,0,0] neg_hi:[1,0,0]
    v_pk_fma_f32 v[110:111], v[102:103], v[150:151], v[110:111]
    v_pk_fma_f32 v[108:109], v[104:105], v[160:161], v[108:109] neg_lo:[1,0,0] neg_hi:[1,0,0]
    v_pk_fma_f32 v[112:113], v[104:105], v[152:153], v[112:113]
    v_cvt_pk_bf16_f32 v86, v106, v107
    v_cvt_pk_bf16_f32 v87, v108, v109
    v_cvt_pk_bf16_f32 v88, -v110, -v111
    v_cvt_pk_bf16_f32 v89, -v112, -v113
L_sp2r:
    v_mfma_f32_16x16x32_bf16 v[90:93], v[82:85], v[46:49], 0
    v_mfma_f32_16x16x32_bf16 v[98:101], v[82:85], v[44:47], 0
    v_mfma_f32_16x16x32_bf16 v[94:97], v[82:85], v[58:61], 0
    v_mfma_f32_16x16x32_bf16 v[102:105], v[82:85], v[56:59], 0
    v_mfma_f32_16x16x32_bf16 v[90:93], v[86:89], v[52:55], v[90:93]
    v_mfma_f32_16x16x32_bf16 v[98:101], v[86:89], v[50:53], v[98:101]
    v_mfma_f32_16x16x32_bf16 v[94:97], v[86:89], v[64:67], v[94:97]
    v_mfma_f32_16x16x32_bf16 v[102:105], v[86:89], v[62:65], v[102:105]
    s_nop 4
    v_pk_mul_f32 v[106:107], v[90:91], v[194:195]
    v_pk_mul_f32 v[110:111], v[90:91], v[202:203]
    v_pk_mul_f32 v[108:109], v[92:93], v[196:197]
    v_pk_mul_f32 v[112:113], v[92:93], v[204:205]
    v_pk_fma_f32 v[106:107], v[98:99], v[202:203], v[106:107] neg_lo:[1,0,0] neg_hi:[1,0,0]
    v_pk_fma_f32 v[110:111], v[98:99], v[194:195], v[110:111]
    v_pk_fma_f32 v[108:109], v[100:101], v[204:205], v[108:109] neg_lo:[1,0,0] neg_hi:[1,0,0]
    v_pk_fma_f32 v[112:113], v[100:101], v[196:197], v[112:113]
    v_cvt_pk_bf16_f32 v82, v106, v107
    v_cvt_pk_bf16_f32 v83, v108, v109
    v_cvt_pk_bf16_f32 v84, v110, v111
    v_cvt_pk_bf16_f32 v85, v112, v113
    ds_write_b128 v24, v[82:85] offset:0
    v_pk_mul_f32 v[106:107], v[94:95], v[198:199]
    v_pk_mul_f32 v[110:111], v[94:95], v[206:207]
    v_pk_mul_f32 v[108:109], v[96:97], v[200:201]
    v_pk_mul_f32 v[112:113], v[96:97], v[208:209]
    v_pk_fma_f32 v[106:107], v[102:103], v[206:207], v[106:107] neg_lo:[1,0,0] neg_hi:[1,0,0]
    v_pk_fma_f32 v[110:111], v[102:103], v[198:199], v[110:111]
    v_pk_fma_f32 v[108:109], v[104:105], v[208:209], v[108:109] neg_lo:[1,0,0] neg_hi:[1,0,0]
    v_pk_fma_f32 v[112:113], v[104:105], v[200:201], v[112:113]
    v_cvt_pk_bf16_f32 v86, v106, v107
    v_cvt_pk_bf16_f32 v87, v108, v109
    v_cvt_pk_bf16_f32 v88, v110, v111
    v_cvt_pk_bf16_f32 v89, v112, v113
    ds_write_b128 v24, v[86:89] offset:4096
    v_mov_b32 v8, 7
    ds_write_b32 v2, v8
    ds_read_b128 v[4:7], v3 offset:0
sw_13:
    s_waitcnt lgkmcnt(0)
    v_min3_u32 v4, v4, v5, v6
    v_min_u32 v4, v4, v7
    s_nop 0
    v_readfirstlane_b32 s57, v4
    s_nop 1
    s_cmp_ge_u32 s57, 7
    s_cbranch_scc1 sd_14
    ds_read_b128 v[4:7], v3 offset:0
    s_branch sw_13
sd_14:
    ds_read_b128 v[114:117], v238 offset:0
    ds_read_b128 v[118:121], v238 offset:1024
    ds_read_b128 v[122:125], v238 offset:2048
    ds_read_b128 v[126:129], v238 offset:3072
    ds_read_b128 v[130:133], v238 offset:4096
    ds_read_b128 v[134:137], v238 offset:5120
    ds_read_b128 v[138:141], v238 offset:6144
    ds_read_b128 v[142:145], v238 offset:7168
    s_waitcnt lgkmcnt(7)
    v_mfma_f32_16x16x32_bf16 v[90:93], v[114:117], v[212:215], 0
    v_mfma_f32_16x16x32_bf16 v[98:101], v[114:117], v[210:213], 0
    s_waitcnt lgkmcnt(6)
    v_mfma_f32_16x16x32_bf16 v[90:93], v[118:121], v[218:221], v[90:93]
    v_mfma_f32_16x16x32_bf16 v[98:101], v[118:121], v[216:219], v[98:101]
    s_waitcnt lgkmcnt(5)
    v_mfma_f32_16x16x32_bf16 v[90:93], v[122:125], v[224:227], v[90:93]
    v_mfma_f32_16x16x32_bf16 v[98:101], v[122:125], v[222:225], v[98:101]
    s_waitcnt lgkmcnt(4)
    v_mfma_f32_16x16x32_bf16 v[90:93], v[126:129], v[230:233], v[90:93]
    v_mfma_f32_16x16x32_bf16 v[98:101], v[126:129], v[228:231], v[98:101]
    s_waitcnt lgkmcnt(3)
    v_mfma_f32_16x16x32_bf16 v[94:97], v[130:133], v[212:215], 0
    v_mfma_f32_16x16x32_bf16 v[102:105], v[130:133], v[210:213], 0
    s_waitcnt lgkmcnt(2)
    v_mfma_f32_16x16x32_bf16 v[94:97], v[134:137], v[218:221], v[94:97]
    v_mfma_f32_16x16x32_bf16 v[102:105], v[134:137], v[216:219], v[102:105]
    s_waitcnt lgkmcnt(1)
    v_mfma_f32_16x16x32_bf16 v[94:97], v[138:141], v[224:227], v[94:97]
    v_mfma_f32_16x16x32_bf16 v[102:105], v[138:141], v[222:225], v[102:105]
    s_waitcnt lgkmcnt(0)
    v_mfma_f32_16x16x32_bf16 v[94:97], v[142:145], v[230:233], v[94:97]
    v_mfma_f32_16x16x32_bf16 v[102:105], v[142:145], v[228:231], v[102:105]
    s_mul_i32 s50, s47, 524288
    s_mul_i32 s51, s42, 128
    s_add_u32 s50, s50, s51
    s_add_u32 s50, s50, 6422528
    s_add_u32 s51, s50, 262144
    v_cvt_pk_bf16_f32 v82, v90, v91
    v_cvt_pk_bf16_f32 v83, v92, v93
    v_cvt_pk_bf16_f32 v84, v98, v99
    v_cvt_pk_bf16_f32 v85, v100, v101
    ds_write_b128 v70, v[82:85]
    v_cvt_pk_bf16_f32 v86, v94, v95
    v_cvt_pk_bf16_f32 v87, v96, v97
    v_cvt_pk_bf16_f32 v88, v102, v103
    v_cvt_pk_bf16_f32 v89, v104, v105
    ds_write_b128 v71, v[86:89]
    ds_read_b128 v[114:117], v81
    ds_read_b128 v[118:121], v81 offset:1024
    s_waitcnt lgkmcnt(1)
    buffer_store_dwordx4 v[114:117], v234, s[36:39], s50 offen sc1
    s_waitcnt lgkmcnt(0)
    buffer_store_dwordx4 v[118:121], v234, s[36:39], s51 offen sc1
    v_add_f32_dpp v237, v237, v237 quad_perm:[1,0,3,2] row_mask:0xf bank_mask:0xf
    s_nop 1
    v_add_f32_dpp v237, v237, v237 quad_perm:[2,3,0,1] row_mask:0xf bank_mask:0xf
    s_nop 1
    v_add_f32_dpp v237, v237, v237 row_half_mirror row_mask:0xf bank_mask:0xf
    v_lshrrev_b32 v10, 3, v0
    s_lshl_b32 s50, s47, 5
    s_add_u32 s50, s50, 114944
    v_lshl_add_u32 v10, v10, 2, s50
    v_cvt_pk_bf16_f32 v237, v237, v237
    v_and_b32 v237, 0xffff0000, v237
    v_mul_f32 v237, 0xbfb8aa3b, v237
    v_exp_f32 v237, v237
    s_nop 0
    v_add_f32 v237, 1.0, v237
    v_rcp_f32 v237, v237
    s_nop 0
    v_cvt_pk_bf16_f32 v237, v237, v237
    v_and_b32 v237, 0xffff0000, v237
    ds_write_b32 v10, v237
    v_mov_b32 v8, 8
    ds_write_b32 v2, v8
    v_and_b32 v242, 31, v0
    v_lshlrev_b32 v243, 2, v242
    v_add_u32 v244, 114944, v243
    v_and_b32 v246, 60, v243
    v_add_u32 v246, 114944, v246
    v_lshrrev_b32 v243, 5, v0
    v_min_u32 v253, 16, v242
    v_mul_u32_u24 v250, 512, v243
    v_lshl_add_u32 v253, v253, 4, v250
    v_bfe_u32 v242, v0, 2, 3
    v_lshl_add_u32 v240, v243, 4, v242
    v_lshlrev_b32 v240, 8, v240
    v_xor_b32 v242, s47, v242
    v_lshl_add_u32 v240, v242, 5, v240
    v_and_b32 v242, 3, v0
    v_lshl_add_u32 v240, v242, 3, v240
    v_xor_b32 v241, 128, v240
    v_bfe_u32 v243, v0, 3, 1
    v_and_b32 v248, 0x70, v1
    v_lshl_add_u32 v248, v243, 14, v248
    v_lshlrev_b32 v234, 7, v243
    v_lshl_add_u32 v234, v242, 4, v234
    v_lshrrev_b32 v243, 4, v0
    v_lshl_add_u32 v248, v243, 7, v248
    s_lshl_b32 s50, s47, 12
    v_add_u32 v248, s50, v248
    v_xor_b32 v249, 64, v248
    s_lshl_b32 s50, s65, 14
    v_and_b32 v242, 0xf0, v1
    v_lshl_add_u32 v250, v243, 9, s50
    v_add_u32 v234, v234, v250
    v_add_u32 v250, v250, v242
    v_bfe_u32 v242, v0, 4, 1
    v_lshl_add_u32 v234, v242, 6, v234
    v_bfe_u32 v242, v0, 2, 1
    v_lshl_add_u32 v234, v242, 3, v234
    v_xor_b32 v235, 64, v234
    v_and_b32 v242, 15, v0
    v_mul_u32_u24 v251, 528, v242
    v_lshl_add_u32 v251, v243, 4, v251
    s_mul_i32 s50, s65, 16896
    s_lshl_b32 s51, s47, 6
    s_add_u32 s50, s50, s51
    s_add_u32 s50, s50, 65536
    v_add_u32 v251, s50, v251
    s_lshl_b32 s50, s46, 2
    v_add_u32 v243, s50, v243
    v_mul_u32_u24 v255, 528, v243
    v_lshl_add_u32 v255, v242, 5, v255
    v_add_u32 v255, 65536, v255
    v_and_b32 v252, 8, v0
    v_mad_u32_u24 v242, v252, 3, v242
    v_lshlrev_b32 v242, 4, v242
    v_lshl_add_u32 v252, v243, 10, v242
    s_lshl_b32 s50, s64, 15
    s_lshl_b32 s14, s47, 13
    s_add_u32 s51, s50, s14
    s_add_u32 s13, s51, 4325376
    s_add_u32 s12, s51, 6422528
    s_add_u32 s14, s14, 8912896
    s_lshl_b32 s15, s49, 7
    s_add_u32 s15, s15, s50
    s_waitcnt vmcnt(0)
    s_mov_b64 exec, 1
    v_mov_b32 v8, 1
    ds_add_rtn_u32 v4, v3, v8 offset:36
    s_waitcnt lgkmcnt(0)
    v_readfirstlane_b32 s57, v4
    s_mov_b64 exec, -1
    s_nop 0
    s_cmp_lg_u32 s57, 3
    s_cbranch_scc1 sig_15
    s_lshl_b32 s56, s40, 8
    s_add_u32 s56, s28, s56
    s_addc_u32 s57, s29, 0
    s_mov_b32 s3, 1
    s_atomic_add s3, s[56:57], 65536
    s_atomic_add s3, s[56:57], 67584
    s_atomic_add s3, s[56:57], 69632
    s_atomic_add s3, s[56:57], 71680
    s_atomic_add s3, s[56:57], 73728
    s_atomic_add s3, s[56:57], 75776
    s_atomic_add s3, s[56:57], 77824
    s_atomic_add s3, s[56:57], 79872
sig_15:
    s_lshl_b32 s50, s49, 6
    s_lshl_b32 s51, s47, 4
    s_add_u32 s50, s50, s51
    v_and_b32 v144, 15, v0
    v_add_u32 v144, s50, v144
    v_cvt_f32_u32 v142, v144
    v_mul_f32 v142, 0x3b000000, v142
    v_lshrrev_b32 v145, 4, v0
    v_lshl_add_u32 v145, v145, 3, s65
    v_cvt_f32_u32 v143, v145
    v_mul_f32 v143, v143, v142
    v_mul_f32 v140, 0x42000000, v142
    v_add_f32 v142, v142, v142
    v_mov_b32 v174, v143
    v_fmamk_f32 v175, v142, 0x3f800000, v143
    v_fmamk_f32 v176, v142, 0x40000000, v143
    v_fmamk_f32 v177, v142, 0x40400000, v143
    v_cos_f32 v170, v174
    v_cos_f32 v171, v175
    v_cos_f32 v172, v176
    v_cos_f32 v173, v177
    v_sin_f32 v174, v174
    v_sin_f32 v175, v175
    v_sin_f32 v176, v176
    v_sin_f32 v177, v177
    v_cos_f32 v138, v140
    v_sin_f32 v140, v140
    v_mov_b32 v139, v138
    v_mov_b32 v141, v140
    v_cvt_pk_bf16_f32 v10, v170, v174
    v_cvt_pk_bf16_f32 v11, v171, v175
    v_cvt_pk_bf16_f32 v12, v172, v176
    v_cvt_pk_bf16_f32 v13, v173, v177
    v_pk_mul_f32 v[178:179], v[170:171], v[138:139]
    v_pk_mul_f32 v[180:181], v[172:173], v[138:139]
    v_pk_mul_f32 v[182:183], v[174:175], v[138:139]
    v_pk_mul_f32 v[184:185], v[176:177], v[138:139]
    v_pk_fma_f32 v[178:179], v[174:175], v[140:141], v[178:179] neg_lo:[1,0,0] neg_hi:[1,0,0]
    v_pk_fma_f32 v[182:183], v[170:171], v[140:141], v[182:183]
    v_pk_fma_f32 v[180:181], v[176:177], v[140:141], v[180:181] neg_lo:[1,0,0] neg_hi:[1,0,0]
    v_pk_fma_f32 v[184:185], v[172:173], v[140:141], v[184:185]
    v_cvt_pk_bf16_f32 v14, v178, v182
    v_cvt_pk_bf16_f32 v15, v179, v183
    v_cvt_pk_bf16_f32 v16, v180, v184
    v_cvt_pk_bf16_f32 v17, v181, v185
    v_pk_mul_f32 v[170:171], v[178:179], v[138:139]
    v_pk_mul_f32 v[172:173], v[180:181], v[138:139]
    v_pk_mul_f32 v[174:175], v[182:183], v[138:139]
    v_pk_mul_f32 v[176:177], v[184:185], v[138:139]
    v_pk_fma_f32 v[170:171], v[182:183], v[140:141], v[170:171] neg_lo:[1,0,0] neg_hi:[1,0,0]
    v_pk_fma_f32 v[174:175], v[178:179], v[140:141], v[174:175]
    v_pk_fma_f32 v[172:173], v[184:185], v[140:141], v[172:173] neg_lo:[1,0,0] neg_hi:[1,0,0]
    v_pk_fma_f32 v[176:177], v[180:181], v[140:141], v[176:177]
    v_cvt_pk_bf16_f32 v18, v170, v174
    v_cvt_pk_bf16_f32 v19, v171, v175
    v_cvt_pk_bf16_f32 v20, v172, v176
    v_cvt_pk_bf16_f32 v21, v173, v177
    v_pk_mul_f32 v[178:179], v[170:171], v[138:139]
    v_pk_mul_f32 v[180:181], v[172:173], v[138:139]
    v_pk_mul_f32 v[182:183], v[174:175], v[138:139]
    v_pk_mul_f32 v[184:185], v[176:177], v[138:139]
    v_pk_fma_f32 v[178:179], v[174:175], v[140:141], v[178:179] neg_lo:[1,0,0] neg_hi:[1,0,0]
    v_pk_fma_f32 v[182:183], v[170:171], v[140:141], v[182:183]
    v_pk_fma_f32 v[180:181], v[176:177], v[140:141], v[180:181] neg_lo:[1,0,0] neg_hi:[1,0,0]
    v_pk_fma_f32 v[184:185], v[172:173], v[140:141], v[184:185]
    v_cvt_pk_bf16_f32 v22, v178, v182
    v_cvt_pk_bf16_f32 v23, v179, v183
    v_cvt_pk_bf16_f32 v24, v180, v184
    v_cvt_pk_bf16_f32 v25, v181, v185
    v_pk_mul_f32 v[170:171], v[178:179], v[138:139]
    v_pk_mul_f32 v[172:173], v[180:181], v[138:139]
    v_pk_mul_f32 v[174:175], v[182:183], v[138:139]
    v_pk_mul_f32 v[176:177], v[184:185], v[138:139]
    v_pk_fma_f32 v[170:171], v[182:183], v[140:141], v[170:171] neg_lo:[1,0,0] neg_hi:[1,0,0]
    v_pk_fma_f32 v[174:175], v[178:179], v[140:141], v[174:175]
    v_pk_fma_f32 v[172:173], v[184:185], v[140:141], v[172:173] neg_lo:[1,0,0] neg_hi:[1,0,0]
    v_pk_fma_f32 v[176:177], v[180:181], v[140:141], v[176:177]
    v_cvt_pk_bf16_f32 v26, v170, v174
    v_cvt_pk_bf16_f32 v27, v171, v175
    v_cvt_pk_bf16_f32 v28, v172, v176
    v_cvt_pk_bf16_f32 v29, v173, v177
    v_pk_mul_f32 v[178:179], v[170:171], v[138:139]
    v_pk_mul_f32 v[180:181], v[172:173], v[138:139]
    v_pk_mul_f32 v[182:183], v[174:175], v[138:139]
    v_pk_mul_f32 v[184:185], v[176:177], v[138:139]
    v_pk_fma_f32 v[178:179], v[174:175], v[140:141], v[178:179] neg_lo:[1,0,0] neg_hi:[1,0,0]
    v_pk_fma_f32 v[182:183], v[170:171], v[140:141], v[182:183]
    v_pk_fma_f32 v[180:181], v[176:177], v[140:141], v[180:181] neg_lo:[1,0,0] neg_hi:[1,0,0]
    v_pk_fma_f32 v[184:185], v[172:173], v[140:141], v[184:185]
    v_cvt_pk_bf16_f32 v30, v178, v182
    v_cvt_pk_bf16_f32 v31, v179, v183
    v_cvt_pk_bf16_f32 v32, v180, v184
    v_cvt_pk_bf16_f32 v33, v181, v185
    v_pk_mul_f32 v[170:171], v[178:179], v[138:139]
    v_pk_mul_f32 v[172:173], v[180:181], v[138:139]
    v_pk_mul_f32 v[174:175], v[182:183], v[138:139]
    v_pk_mul_f32 v[176:177], v[184:185], v[138:139]
    v_pk_fma_f32 v[170:171], v[182:183], v[140:141], v[170:171] neg_lo:[1,0,0] neg_hi:[1,0,0]
    v_pk_fma_f32 v[174:175], v[178:179], v[140:141], v[174:175]
    v_pk_fma_f32 v[172:173], v[184:185], v[140:141], v[172:173] neg_lo:[1,0,0] neg_hi:[1,0,0]
    v_pk_fma_f32 v[176:177], v[180:181], v[140:141], v[176:177]
    v_cvt_pk_bf16_f32 v34, v170, v174
    v_cvt_pk_bf16_f32 v35, v171, v175
    v_cvt_pk_bf16_f32 v36, v172, v176
    v_cvt_pk_bf16_f32 v37, v173, v177
    v_pk_mul_f32 v[178:179], v[170:171], v[138:139]
    v_pk_mul_f32 v[180:181], v[172:173], v[138:139]
    v_pk_mul_f32 v[182:183], v[174:175], v[138:139]
    v_pk_mul_f32 v[184:185], v[176:177], v[138:139]
    v_pk_fma_f32 v[178:179], v[174:175], v[140:141], v[178:179] neg_lo:[1,0,0] neg_hi:[1,0,0]
    v_pk_fma_f32 v[182:183], v[170:171], v[140:141], v[182:183]
    v_pk_fma_f32 v[180:181], v[176:177], v[140:141], v[180:181] neg_lo:[1,0,0] neg_hi:[1,0,0]
    v_pk_fma_f32 v[184:185], v[172:173], v[140:141], v[184:185]
    v_cvt_pk_bf16_f32 v38, v178, v182
    v_cvt_pk_bf16_f32 v39, v179, v183
    v_cvt_pk_bf16_f32 v40, v180, v184
    v_cvt_pk_bf16_f32 v41, v181, v185
    v_lshlrev_b32 v144, 31, v144
    v_xor_b32 v144, 0xbf003f00, v144
    v_cmp_eq_u32 vcc, 0, v145
    s_nop 1
    v_cndmask_b32 v10, v10, v144, vcc
    ds_read_b128 v[4:7], v3 offset:16
sw_16:
    s_waitcnt lgkmcnt(0)
    v_min3_u32 v4, v4, v5, v6
    v_min_u32 v4, v4, v7
    s_nop 0
    v_readfirstlane_b32 s57, v4
    s_nop 1
    s_cmp_ge_u32 s57, 15
    s_cbranch_scc1 sd_17
    ds_read_b128 v[4:7], v3 offset:16
    s_branch sw_16
sd_17:
    v_add_u32 v156, 57344, v240
    v_add_u32 v157, 57344, v241
    v_add_u32 v158, 114688, v240
    v_add_u32 v159, 114688, v241
    ds_read_b64_tr_b16 v[74:75], v158 offset:27392
    ds_read_b64_tr_b16 v[76:77], v158 offset:29440
    ds_read_b64_tr_b16 v[78:79], v159 offset:27392
    ds_read_b64_tr_b16 v[80:81], v159 offset:29440
    ds_read_b64_tr_b16 v[82:83], v156 offset:32768
    ds_read_b64_tr_b16 v[84:85], v156 offset:34816
    ds_read_b64_tr_b16 v[86:87], v157 offset:32768
    ds_read_b64_tr_b16 v[88:89], v157 offset:34816
    ds_read_b64_tr_b16 v[90:91], v156 offset:40960
    ds_read_b64_tr_b16 v[92:93], v156 offset:43008
    ds_read_b64_tr_b16 v[94:95], v157 offset:40960
    ds_read_b64_tr_b16 v[96:97], v157 offset:43008
    ds_read_b64_tr_b16 v[98:99], v156 offset:49152
    ds_read_b64_tr_b16 v[100:101], v156 offset:51200
    ds_read_b64_tr_b16 v[102:103], v157 offset:49152
    ds_read_b64_tr_b16 v[104:105], v157 offset:51200
    ds_read_b64_tr_b16 v[106:107], v240 offset:0
    ds_read_b64_tr_b16 v[108:109], v240 offset:2048
    ds_read_b64_tr_b16 v[110:111], v241 offset:0
    ds_read_b64_tr_b16 v[112:113], v241 offset:2048
    ds_read_b64_tr_b16 v[114:115], v240 offset:8192
    ds_read_b64_tr_b16 v[116:117], v240 offset:10240
    ds_read_b64_tr_b16 v[118:119], v241 offset:8192
    ds_read_b64_tr_b16 v[120:121], v241 offset:10240
    ds_read_b64_tr_b16 v[122:123], v240 offset:16384
    ds_read_b64_tr_b16 v[124:125], v240 offset:18432
    ds_read_b64_tr_b16 v[126:127], v241 offset:16384
    ds_read_b64_tr_b16 v[128:129], v241 offset:18432
    ds_read_b64_tr_b16 v[130:131], v240 offset:24576
    ds_read_b64_tr_b16 v[132:133], v240 offset:26624
    ds_read_b64_tr_b16 v[134:135], v241 offset:24576
    ds_read_b64_tr_b16 v[136:137], v241 offset:26624
    s_mov_b32 s58, 0
    s_mov_b32 s63, 0
    s_atomic_add s63, s[30:31], 65536 glc
    s_mov_b32 s52, 0
    s_atomic_add s52, s[30:31], 65792 glc
    s_branch yd_19
yg_18:
    buffer_load_dwordx4 v[42:45], v1, s[36:39], s12 offen offset:0 sc1
    buffer_load_dwordx4 v[46:49], v1, s[36:39], s12 offen offset:1024 sc1
    buffer_load_dwordx4 v[50:53], v1, s[36:39], s12 offen offset:2048 sc1
    buffer_load_dwordx4 v[54:57], v1, s[36:39], s12 offen offset:3072 sc1
    s_add_u32 s12, s12, 4096
    buffer_load_dwordx4 v[58:61], v1, s[36:39], s12 offen offset:0 sc1
    buffer_load_dwordx4 v[62:65], v1, s[36:39], s12 offen offset:1024 sc1
    buffer_load_dwordx4 v[66:69], v1, s[36:39], s12 offen offset:2048 sc1
    buffer_load_dwordx4 v[70:73], v1, s[36:39], s12 offen offset:3072 sc1
    s_mov_b32 s58, 1
yd_19:
    s_branch L_FIN
L_G1:
    s_mov_b32 s38, 9437184
    s_mov_b32 s39, 0x20000
    s_mov_b32 s26, 524288
    s_mov_b32 s27, 0x20000
    s_mov_b32 s34, 2097152
    s_mov_b32 s35, 0x20000
    s_lshr_b32 s64, s44, 5
    s_add_u32 s64, s64, s48
    s_lshr_b32 s65, s46, 2
    s_add_u32 s28, s36, 8978432
    s_addc_u32 s29, s37, 0
    s_mul_i32 s50, s42, 8
    s_lshr_b32 s50, s50, 8
    s_lshl_b32 s50, s50, 11
    s_lshl_b32 s51, s47, 9
    s_add_u32 s50, s50, s51
    s_add_u32 s30, s28, s50
    s_addc_u32 s31, s29, 0
    s_lshl_b32 s50, s49, 6
    s_lshl_b32 s51, s47, 4
    s_add_u32 s50, s50, s51
    v_and_b32 v240, 15, v0
    v_add_u32 v240, s50, v240
    v_cvt_f32_u32 v238, v240
    v_mul_f32 v238, 0x3b000000, v238
    v_lshrrev_b32 v241, 4, v0
    v_lshl_add_u32 v241, v241, 3, s65
    v_cvt_f32_u32 v239, v241
    v_mul_f32 v239, v239, v238
    v_mul_f32 v236, 0x42000000, v238
    v_add_f32 v238, v238, v238
    v_mov_b32 v222, v239
    v_fmamk_f32 v223, v238, 0x3f800000, v239
    v_fmamk_f32 v224, v238, 0x40000000, v239
    v_fmamk_f32 v225, v238, 0x40400000, v239
    v_cos_f32 v218, v222
    v_cos_f32 v219, v223
    v_cos_f32 v220, v224
    v_cos_f32 v221, v225
    v_sin_f32 v222, v222
    v_sin_f32 v223, v223
    v_sin_f32 v224, v224
    v_sin_f32 v225, v225
    v_cos_f32 v234, v236
    v_sin_f32 v236, v236
    v_mov_b32 v235, v234
    v_mov_b32 v237, v236
    v_cvt_pk_bf16_f32 v10, v218, v222
    v_cvt_pk_bf16_f32 v11, v219, v223
    v_cvt_pk_bf16_f32 v12, v220, v224
    v_cvt_pk_bf16_f32 v13, v221, v225
    v_pk_mul_f32 v[226:227], v[218:219], v[234:235]
    v_pk_mul_f32 v[228:229], v[220:221], v[234:235]
    v_pk_mul_f32 v[230:231], v[222:223], v[234:235]
    v_pk_mul_f32 v[232:233], v[224:225], v[234:235]
    v_pk_fma_f32 v[226:227], v[222:223], v[236:237], v[226:227] neg_lo:[1,0,0] neg_hi:[1,0,0]
    v_pk_fma_f32 v[230:231], v[218:219], v[236:237], v[230:231]
    v_pk_fma_f32 v[228:229], v[224:225], v[236:237], v[228:229] neg_lo:[1,0,0] neg_hi:[1,0,0]
    v_pk_fma_f32 v[232:233], v[220:221], v[236:237], v[232:233]
    v_cvt_pk_bf16_f32 v14, v226, v230
    v_cvt_pk_bf16_f32 v15, v227, v231
    v_cvt_pk_bf16_f32 v16, v228, v232
    v_cvt_pk_bf16_f32 v17, v229, v233
    v_pk_mul_f32 v[218:219], v[226:227], v[234:235]
    v_pk_mul_f32 v[220:221], v[228:229], v[234:235]
    v_pk_mul_f32 v[222:223], v[230:231], v[234:235]
    v_pk_mul_f32 v[224:225], v[232:233], v[234:235]
    v_pk_fma_f32 v[218:219], v[230:231], v[236:237], v[218:219] neg_lo:[1,0,0] neg_hi:[1,0,0]
    v_pk_fma_f32 v[222:223], v[226:227], v[236:237], v[222:223]
    v_pk_fma_f32 v[220:221], v[232:233], v[236:237], v[220:221] neg_lo:[1,0,0] neg_hi:[1,0,0]
    v_pk_fma_f32 v[224:225], v[228:229], v[236:237], v[224:225]
    v_cvt_pk_bf16_f32 v18, v218, v222
    v_cvt_pk_bf16_f32 v19, v219, v223
    v_cvt_pk_bf16_f32 v20, v220, v224
    v_cvt_pk_bf16_f32 v21, v221, v225
    v_pk_mul_f32 v[226:227], v[218:219], v[234:235]
    v_pk_mul_f32 v[228:229], v[220:221], v[234:235]
    v_pk_mul_f32 v[230:231], v[222:223], v[234:235]
    v_pk_mul_f32 v[232:233], v[224:225], v[234:235]
    v_pk_fma_f32 v[226:227], v[222:223], v[236:237], v[226:227] neg_lo:[1,0,0] neg_hi:[1,0,0]
    v_pk_fma_f32 v[230:231], v[218:219], v[236:237], v[230:231]
    v_pk_fma_f32 v[228:229], v[224:225], v[236:237], v[228:229] neg_lo:[1,0,0] neg_hi:[1,0,0]
    v_pk_fma_f32 v[232:233], v[220:221], v[236:237], v[232:233]
    v_cvt_pk_bf16_f32 v22, v226, v230
    v_cvt_pk_bf16_f32 v23, v227, v231
    v_cvt_pk_bf16_f32 v24, v228, v232
    v_cvt_pk_bf16_f32 v25, v229, v233
    v_pk_mul_f32 v[218:219], v[226:227], v[234:235]
    v_pk_mul_f32 v[220:221], v[228:229], v[234:235]
    v_pk_mul_f32 v[222:223], v[230:231], v[234:235]
    v_pk_mul_f32 v[224:225], v[232:233], v[234:235]
    v_pk_fma_f32 v[218:219], v[230:231], v[236:237], v[218:219] neg_lo:[1,0,0] neg_hi:[1,0,0]
    v_pk_fma_f32 v[222:223], v[226:227], v[236:237], v[222:223]
    v_pk_fma_f32 v[220:221], v[232:233], v[236:237], v[220:221] neg_lo:[1,0,0] neg_hi:[1,0,0]
    v_pk_fma_f32 v[224:225], v[228:229], v[236:237], v[224:225]
    v_cvt_pk_bf16_f32 v26, v218, v222
    v_cvt_pk_bf16_f32 v27, v219, v223
    v_cvt_pk_bf16_f32 v28, v220, v224
    v_cvt_pk_bf16_f32 v29, v221, v225
    v_pk_mul_f32 v[226:227], v[218:219], v[234:235]
    v_pk_mul_f32 v[228:229], v[220:221], v[234:235]
    v_pk_mul_f32 v[230:231], v[222:223], v[234:235]
    v_pk_mul_f32 v[232:233], v[224:225], v[234:235]
    v_pk_fma_f32 v[226:227], v[222:223], v[236:237], v[226:227] neg_lo:[1,0,0] neg_hi:[1,0,0]
    v_pk_fma_f32 v[230:231], v[218:219], v[236:237], v[230:231]
    v_pk_fma_f32 v[228:229], v[224:225], v[236:237], v[228:229] neg_lo:[1,0,0] neg_hi:[1,0,0]
    v_pk_fma_f32 v[232:233], v[220:221], v[236:237], v[232:233]
    v_cvt_pk_bf16_f32 v30, v226, v230
    v_cvt_pk_bf16_f32 v31, v227, v231
    v_cvt_pk_bf16_f32 v32, v228, v232
    v_cvt_pk_bf16_f32 v33, v229, v233
    v_pk_mul_f32 v[218:219], v[226:227], v[234:235]
    v_pk_mul_f32 v[220:221], v[228:229], v[234:235]
    v_pk_mul_f32 v[222:223], v[230:231], v[234:235]
    v_pk_mul_f32 v[224:225], v[232:233], v[234:235]
    v_pk_fma_f32 v[218:219], v[230:231], v[236:237], v[218:219] neg_lo:[1,0,0] neg_hi:[1,0,0]
    v_pk_fma_f32 v[222:223], v[226:227], v[236:237], v[222:223]
    v_pk_fma_f32 v[220:221], v[232:233], v[236:237], v[220:221] neg_lo:[1,0,0] neg_hi:[1,0,0]
    v_pk_fma_f32 v[224:225], v[228:229], v[236:237], v[224:225]
    v_cvt_pk_bf16_f32 v34, v218, v222
    v_cvt_pk_bf16_f32 v35, v219, v223
    v_cvt_pk_bf16_f32 v36, v220, v224
    v_cvt_pk_bf16_f32 v37, v221, v225
    v_pk_mul_f32 v[226:227], v[218:219], v[234:235]
    v_pk_mul_f32 v[228:229], v[220:221], v[234:235]
    v_pk_mul_f32 v[230:231], v[222:223], v[234:235]
    v_pk_mul_f32 v[232:233], v[224:225], v[234:235]
    v_pk_fma_f32 v[226:227], v[222:223], v[236:237], v[226:227] neg_lo:[1,0,0] neg_hi:[1,0,0]
    v_pk_fma_f32 v[230:231], v[218:219], v[236:237], v[230:231]
    v_pk_fma_f32 v[228:229], v[224:225], v[236:237], v[228:229] neg_lo:[1,0,0] neg_hi:[1,0,0]
    v_pk_fma_f32 v[232:233], v[220:221], v[236:237], v[232:233]
    v_cvt_pk_bf16_f32 v38, v226, v230
    v_cvt_pk_bf16_f32 v39, v227, v231
    v_cvt_pk_bf16_f32 v40, v228, v232
    v_cvt_pk_bf16_f32 v41, v229, v233
    v_lshlrev_b32 v240, 31, v240
    v_xor_b32 v240, 0xbf003f00, v240
    v_cmp_eq_u32 vcc, 0, v241
    s_nop 1
    v_cndmask_b32 v10, v10, v240, vcc
    v_and_b32 v242, 31, v0
    v_lshlrev_b32 v243, 2, v242
    v_add_u32 v244, 114944, v243
    v_and_b32 v246, 60, v243
    v_add_u32 v246, 114944, v246
    v_lshrrev_b32 v243, 5, v0
    v_min_u32 v253, 16, v242
    v_mul_u32_u24 v250, 512, v243
    v_lshl_add_u32 v253, v253, 4, v250
    v_bfe_u32 v242, v0, 2, 3
    v_lshl_add_u32 v240, v243, 4, v242
    v_lshlrev_b32 v240, 8, v240
    v_xor_b32 v242, s47, v242
    v_lshl_add_u32 v240, v242, 5, v240
    v_and_b32 v242, 3, v0
    v_lshl_add_u32 v240, v242, 3, v240
    v_xor_b32 v241, 128, v240
    v_bfe_u32 v243, v0, 3, 1
    v_and_b32 v248, 0x70, v1
    v_lshl_add_u32 v248, v243, 14, v248
    v_lshlrev_b32 v234, 7, v243
    v_lshl_add_u32 v234, v242, 4, v234
    v_lshrrev_b32 v243, 4, v0
    v_lshl_add_u32 v248, v243, 7, v248
    s_lshl_b32 s50, s47, 12
    v_add_u32 v248, s50, v248
    v_xor_b32 v249, 64, v248
    s_lshl_b32 s50, s65, 14
    v_and_b32 v242, 0xf0, v1
    v_lshl_add_u32 v250, v243, 9, s50
    v_add_u32 v234, v234, v250
    v_add_u32 v250, v250, v242
    v_bfe_u32 v242, v0, 4, 1
    v_lshl_add_u32 v234, v242, 6, v234
    v_bfe_u32 v242, v0, 2, 1
    v_lshl_add_u32 v234, v242, 3, v234
    v_xor_b32 v235, 64, v234
    v_and_b32 v242, 15, v0
    v_mul_u32_u24 v251, 528, v242
    v_lshl_add_u32 v251, v243, 4, v251
    s_mul_i32 s50, s65, 16896
    s_lshl_b32 s51, s47, 6
    s_add_u32 s50, s50, s51
    s_add_u32 s50, s50, 65536
    v_add_u32 v251, s50, v251
    s_lshl_b32 s50, s46, 2
    v_add_u32 v243, s50, v243
    v_mul_u32_u24 v255, 528, v243
    v_lshl_add_u32 v255, v242, 5, v255
    v_add_u32 v255, 65536, v255
    v_and_b32 v252, 8, v0
    v_mad_u32_u24 v242, v252, 3, v242
    v_lshlrev_b32 v242, 4, v242
    v_lshl_add_u32 v252, v243, 10, v242
    s_lshl_b32 s50, s64, 15
    s_lshl_b32 s14, s47, 13
    s_add_u32 s51, s50, s14
    s_add_u32 s13, s51, 4325376
    s_add_u32 s12, s51, 6422528
    s_add_u32 s14, s14, 8912896
    s_lshl_b32 s15, s49, 7
    s_add_u32 s15, s15, s50
    v_bfe_u32 v199, v0, 1, 3
    v_lshrrev_b32 v198, 4, v0
    v_xor_b32 v199, v199, v198
    v_lshlrev_b32 v199, 4, v199
    v_and_b32 v200, 15, v0
    v_lshl_add_u32 v200, v200, 7, v199
    v_xor_b32 v201, 64, v200
    v_add_u32 v202, 65536, v200
    v_add_u32 v203, 65536, v201
    v_lshrrev_b32 v198, 5, v0
    v_lshlrev_b32 v204, 12, v198
    v_bfe_u32 v199, v0, 4, 1
    v_lshl_add_u32 v204, v199, 10, v204
    v_bfe_u32 v199, v0, 2, 2
    v_lshl_add_u32 v204, v199, 7, v204
    v_bfe_u32 v199, v0, 3, 2
    v_xor_b32 v199, s47, v199
    v_lshl_add_u32 v204, v199, 5, v204
    v_and_b32 v199, 3, v0
    v_lshl_add_u32 v204, v199, 3, v204
    v_add_u32 v205, 65536, v204
    s_mov_b32 s60, 0x3fb8aa3b
    s_mov_b32 s61, 0x3fb8aa3b
    s_mul_i32 s50, s47, 1088
    s_add_u32 s51, s50, 142080
    v_add_u32 v206, s51, v1
    v_add_u32 v210, s51, v0
    v_lshrrev_b32 v198, 2, v0
    v_mul_u32_u24 v198, 240, v198
    v_lshl_add_u32 v211, v0, 2, v198
    v_add_u32 v211, 32768, v211
    v_and_b32 v199, 0xf0, v1
    v_lshlrev_b32 v208, 2, v0
    v_add_u32 v207, s51, v208
    v_lshrrev_b32 v198, 4, v0
    v_lshl_add_u32 v208, v198, 2, v199
    v_bfe_u32 v198, v0, 4, 1
    v_lshl_add_u32 v209, v198, 9, v199
    v_lshrrev_b32 v198, 5, v0
    v_lshl_add_u32 v209, v198, 8, v209
    v_lshrrev_b32 v198, 4, v0
    v_lshlrev_b32 v222, 5, v198
    v_xor_b32 v199, v199, v222
    v_and_b32 v222, 128, v199
    v_mad_u32_u24 v199, v222, 3, v199
    v_lshl_add_u32 v222, v198, 10, v199
    v_xor_b32 v223, 512, v222
    v_add_u32 v223, 3072, v223
    s_lshl_b32 s51, s43, 12
    s_lshl_b32 s50, s47, 10
    s_add_u32 s50, s50, s51
    s_add_u32 s50, s50, 8912896
    s_lshl_b32 s52, s44, 10
    s_xor_b32 s51, s43, 0
    s_lshl_b32 s51, s51, 12
    s_add_u32 s52, s52, s51
    s_lshl_b32 s51, s47, 10
    s_add_u32 s52, s52, s51
    s_add_u32 s52, s52, 4325376
    s_lshl_b32 s51, s49, 7
    s_lshl_b32 s54, s47, 13
    s_add_u32 s54, s54, s51
    s_lshr_b32 s55, s41, 2
    v_mov_b32 v218, 0xc2800000
    v_mov_b32 v219, 0xc2800000
    v_mov_b32 v220, 0xc2800000
    v_mov_b32 v221, 0xc2800000
    v_mov_b32 v212, 0x3f803f80
    v_mov_b32 v213, 0x3f803f80
    v_mov_b32 v214, 0x3f803f80
    v_mov_b32 v215, 0x3f803f80
    s_add_u32 m0, s67, 34816
    s_add_u32 s6, s45, 1
    s_and_b32 s6, s6, 7
    s_lshl_b32 s6, s6, 7
    s_mul_i32 s7, s6, 1536
    buffer_load_dwordx4 v194, s[8:11], s6 offen lds
    buffer_load_dwordx4 v195, s[8:11], s6 offen offset:1024 lds
    s_add_u32 m0, s67, 32768
    s_nop 0
    buffer_load_dwordx4 v190, s[20:23], s7 offen lds
    buffer_load_dwordx4 v191, s[20:23], s7 offen offset:1024 lds
    s_waitcnt vmcnt(4) lgkmcnt(0)
    s_barrier
    ds_read_b64_tr_b16 v[58:59], v204 offset:0
    ds_read_b64_tr_b16 v[60:61], v204 offset:512
    ds_read_b128 v[42:45], v200 offset:2048
    ds_read_b128 v[46:49], v200 offset:6144
    ds_read_b64_tr_b16 v[62:63], v204 offset:18432
    ds_read_b64_tr_b16 v[64:65], v204 offset:18944
    ds_read_b128 v[50:53], v200 offset:10240
    ds_read_b128 v[54:57], v200 offset:14336
    ds_read_b64_tr_b16 v[66:67], v204 offset:16384
    ds_read_b64_tr_b16 v[68:69], v204 offset:16896
    ds_read_b64_tr_b16 v[86:87], v204 offset:8192
    ds_read_b64_tr_b16 v[88:89], v204 offset:8704
    ds_read_b128 v[70:73], v201 offset:2048
    ds_read_b128 v[74:77], v201 offset:6144
    ds_read_b64_tr_b16 v[90:91], v204 offset:26624
    s_add_u32 m0, s67, 49152
    s_waitcnt vmcnt(11)
    buffer_load_dwordx4 v192, s[20:23], s7 offen offset:2048 lds
    s_waitcnt vmcnt(11)
    buffer_load_dwordx4 v193, s[20:23], s7 offen offset:3072 lds
    s_waitcnt vmcnt(11)
    buffer_load_dwordx4 v192, s[20:23], s7 offen lds
    s_waitcnt vmcnt(11)
    buffer_load_dwordx4 v193, s[20:23], s7 offen offset:1024 lds
    s_waitcnt lgkmcnt(5)
    v_mfma_f32_16x16x32_bf16 v[126:129], v[42:45], v[58:61], 0
    ds_read_b64_tr_b16 v[92:93], v204 offset:27136
    v_mfma_f32_16x16x32_bf16 v[130:133], v[46:49], v[58:61], 0
    ds_read_b128 v[78:81], v201 offset:10240
    v_mfma_f32_16x16x32_bf16 v[134:137], v[50:53], v[58:61], 0
    ds_read_b128 v[82:85], v201 offset:14336
    v_mfma_f32_16x16x32_bf16 v[138:141], v[54:57], v[58:61], 0
    ds_read_b64_tr_b16 v[94:95], v204 offset:24576
    v_mfma_f32_16x16x32_bf16 v[142:145], v[42:45], v[62:65], 0
    ds_read_b64_tr_b16 v[96:97], v204 offset:25088
    v_mfma_f32_16x16x32_bf16 v[146:149], v[46:49], v[62:65], 0
    s_add_u32 m0, s67, 67584
    s_add_u32 s6, s45, 2
    s_and_b32 s6, s6, 7
    s_lshl_b32 s6, s6, 7
    s_mul_i32 s7, s6, 1536
    s_waitcnt vmcnt(11)
    buffer_load_dwordx4 v194, s[8:11], s6 offen lds
    v_mfma_f32_16x16x32_bf16 v[150:153], v[50:53], v[62:65], 0
    v_mfma_f32_16x16x32_bf16 v[154:157], v[54:57], v[62:65], 0
    s_waitcnt vmcnt(11)
    buffer_load_dwordx4 v195, s[8:11], s6 offen offset:1024 lds
    v_mfma_f32_16x16x32_bf16 v[158:161], v[66:69], v[42:45], 0
    v_mfma_f32_16x16x32_bf16 v[162:165], v[66:69], v[46:49], 0
    s_add_u32 m0, s67, 65536
    s_waitcnt vmcnt(11)
    buffer_load_dwordx4 v190, s[20:23], s7 offen lds
    v_mfma_f32_16x16x32_bf16 v[166:169], v[66:69], v[50:53], 0
    v_mfma_f32_16x16x32_bf16 v[170:173], v[66:69], v[54:57], 0
    s_waitcnt vmcnt(11)
    buffer_load_dwordx4 v191, s[20:23], s7 offen offset:1024 lds
    s_waitcnt lgkmcnt(0)
    v_mfma_f32_16x16x32_bf16 v[126:129], v[70:73], v[86:89], v[126:129]
    s_add_u32 m0, s67, 81920
    s_waitcnt vmcnt(11)
    buffer_load_dwordx4 v192, s[20:23], s7 offen offset:2048 lds
    v_mfma_f32_16x16x32_bf16 v[130:133], v[74:77], v[86:89], v[130:133]
    v_mfma_f32_16x16x32_bf16 v[134:137], v[78:81], v[86:89], v[134:137]
    v_mfma_f32_16x16x32_bf16 v[138:141], v[82:85], v[86:89], v[138:141]
    s_waitcnt vmcnt(11)
    buffer_load_dwordx4 v193, s[20:23], s7 offen offset:3072 lds
    v_mfma_f32_16x16x32_bf16 v[142:145], v[70:73], v[90:93], v[142:145]
    v_mfma_f32_16x16x32_bf16 v[146:149], v[74:77], v[90:93], v[146:149]
    s_waitcnt vmcnt(11)
    buffer_load_dwordx4 v192, s[20:23], s7 offen lds
    s_waitcnt vmcnt(11)
    buffer_load_dwordx4 v193, s[20:23], s7 offen offset:1024 lds
    s_add_u32 m0, s67, 100352
    s_add_u32 s6, s45, 3
    s_and_b32 s6, s6, 7
    s_lshl_b32 s6, s6, 7
    s_mul_i32 s7, s6, 1536
    s_waitcnt vmcnt(11)
    buffer_load_dwordx4 v194, s[8:11], s6 offen lds
    s_waitcnt vmcnt(11)
    buffer_load_dwordx4 v195, s[8:11], s6 offen offset:1024 lds
    s_add_u32 m0, s67, 98304
    s_waitcnt vmcnt(11)
    buffer_load_dwordx4 v190, s[20:23], s7 offen lds
    s_waitcnt vmcnt(11)
    buffer_load_dwordx4 v191, s[20:23], s7 offen offset:1024 lds
    s_waitcnt vmcnt(12) lgkmcnt(0)
    s_barrier
    ds_read_b64_tr_b16 v[114:115], v204 offset:32768
    ds_read_b64_tr_b16 v[116:117], v204 offset:33280
    ds_read_b128 v[98:101], v200 offset:34816
    ds_read_b128 v[102:105], v200 offset:38912
    ds_read_b64_tr_b16 v[118:119], v204 offset:51200
    ds_read_b64_tr_b16 v[120:121], v204 offset:51712
    ds_read_b128 v[106:109], v200 offset:43008
    ds_read_b128 v[110:113], v200 offset:47104
    ds_read_b64_tr_b16 v[122:123], v204 offset:49152
    ds_read_b64_tr_b16 v[124:125], v204 offset:49664
    ds_read_b64_tr_b16 v[58:59], v204 offset:40960
    ds_read_b64_tr_b16 v[60:61], v204 offset:41472
    ds_read_b128 v[42:45], v201 offset:34816
    ds_read_b128 v[46:49], v201 offset:38912
    ds_read_b64_tr_b16 v[62:63], v204 offset:59392
    v_mfma_f32_16x16x32_bf16 v[150:153], v[78:81], v[90:93], v[150:153]
    s_add_u32 m0, s67, 0
    s_waitcnt vmcnt(11)
    buffer_load_dwordx4 v192, s[20:23], s7 offen offset:2048 lds
    v_mfma_f32_16x16x32_bf16 v[154:157], v[82:85], v[90:93], v[154:157]
    v_mfma_f32_16x16x32_bf16 v[158:161], v[94:97], v[70:73], v[158:161]
    v_mfma_f32_16x16x32_bf16 v[162:165], v[94:97], v[74:77], v[162:165]
    s_waitcnt vmcnt(11)
    buffer_load_dwordx4 v193, s[20:23], s7 offen offset:3072 lds
    v_mfma_f32_16x16x32_bf16 v[166:169], v[94:97], v[78:81], v[166:169]
    v_mfma_f32_16x16x32_bf16 v[170:173], v[94:97], v[82:85], v[170:173]
    s_waitcnt lgkmcnt(5)
    v_mfma_f32_16x16x32_bf16 v[126:129], v[98:101], v[114:117], v[126:129]
    ds_read_b64_tr_b16 v[64:65], v204 offset:59904
    v_mfma_f32_16x16x32_bf16 v[130:133], v[102:105], v[114:117], v[130:133]
    ds_read_b128 v[50:53], v201 offset:43008
    v_mfma_f32_16x16x32_bf16 v[134:137], v[106:109], v[114:117], v[134:137]
    ds_read_b128 v[54:57], v201 offset:47104
    v_mfma_f32_16x16x32_bf16 v[138:141], v[110:113], v[114:117], v[138:141]
    ds_read_b64_tr_b16 v[66:67], v204 offset:57344
    v_mfma_f32_16x16x32_bf16 v[142:145], v[98:101], v[118:121], v[142:145]
    ds_read_b64_tr_b16 v[68:69], v204 offset:57856
    v_mfma_f32_16x16x32_bf16 v[146:149], v[102:105], v[118:121], v[146:149]
    s_waitcnt vmcnt(11)
    buffer_load_dwordx4 v192, s[20:23], s7 offen lds
    v_mfma_f32_16x16x32_bf16 v[150:153], v[106:109], v[118:121], v[150:153]
    v_mfma_f32_16x16x32_bf16 v[154:157], v[110:113], v[118:121], v[154:157]
    s_waitcnt vmcnt(11)
    buffer_load_dwordx4 v193, s[20:23], s7 offen offset:1024 lds
    v_mfma_f32_16x16x32_bf16 v[158:161], v[122:125], v[98:101], v[158:161]
    v_mfma_f32_16x16x32_bf16 v[162:165], v[122:125], v[102:105], v[162:165]
    v_mfma_f32_16x16x32_bf16 v[166:169], v[122:125], v[106:109], v[166:169]
    v_mfma_f32_16x16x32_bf16 v[170:173], v[122:125], v[110:113], v[170:173]
    s_waitcnt lgkmcnt(0)
    v_mfma_f32_16x16x32_bf16 v[126:129], v[42:45], v[58:61], v[126:129]
    v_mfma_f32_16x16x32_bf16 v[130:133], v[46:49], v[58:61], v[130:133]
    v_mfma_f32_16x16x32_bf16 v[134:137], v[50:53], v[58:61], v[134:137]
    v_mfma_f32_16x16x32_bf16 v[138:141], v[54:57], v[58:61], v[138:141]
    v_mfma_f32_16x16x32_bf16 v[142:145], v[42:45], v[62:65], v[142:145]
    v_mfma_f32_16x16x32_bf16 v[146:149], v[46:49], v[62:65], v[146:149]
    s_waitcnt vmcnt(8) lgkmcnt(0)
    s_barrier
    ds_read_b64_tr_b16 v[86:87], v205 offset:0
    ds_read_b64_tr_b16 v[88:89], v205 offset:512
    ds_read_b128 v[70:73], v202 offset:2048
    ds_read_b128 v[74:77], v202 offset:6144
    ds_read_b64_tr_b16 v[90:91], v205 offset:18432
    ds_read_b64_tr_b16 v[92:93], v205 offset:18944
    ds_read_b128 v[78:81], v202 offset:10240
    ds_read_b128 v[82:85], v202 offset:14336
    ds_read_b64_tr_b16 v[94:95], v205 offset:16384
    ds_read_b64_tr_b16 v[96:97], v205 offset:16896
    ds_read_b64_tr_b16 v[114:115], v205 offset:8192
    ds_read_b64_tr_b16 v[116:117], v205 offset:8704
    ds_read_b128 v[98:101], v203 offset:2048
    ds_read_b128 v[102:105], v203 offset:6144
    ds_read_b64_tr_b16 v[118:119], v205 offset:26624
    v_mfma_f32_16x16x32_bf16 v[150:153], v[50:53], v[62:65], v[150:153]
    s_add_u32 m0, s67, 18432
    s_add_u32 s6, s45, 4
    s_and_b32 s6, s6, 7
    s_lshl_b32 s6, s6, 7
    s_mul_i32 s7, s6, 1536
    s_waitcnt vmcnt(11)
    buffer_load_dwordx4 v194, s[8:11], s6 offen lds
    v_mfma_f32_16x16x32_bf16 v[154:157], v[54:57], v[62:65], v[154:157]
    v_mfma_f32_16x16x32_bf16 v[158:161], v[66:69], v[42:45], v[158:161]
    v_mfma_f32_16x16x32_bf16 v[162:165], v[66:69], v[46:49], v[162:165]
    s_waitcnt vmcnt(11)
    buffer_load_dwordx4 v195, s[8:11], s6 offen offset:1024 lds
    v_mfma_f32_16x16x32_bf16 v[166:169], v[66:69], v[50:53], v[166:169]
    v_mfma_f32_16x16x32_bf16 v[170:173], v[66:69], v[54:57], v[170:173]
    s_waitcnt lgkmcnt(5)
    v_mfma_f32_16x16x32_bf16 v[126:129], v[70:73], v[86:89], v[126:129]
    ds_read_b64_tr_b16 v[120:121], v205 offset:27136
    v_mfma_f32_16x16x32_bf16 v[130:133], v[74:77], v[86:89], v[130:133]
    ds_read_b128 v[106:109], v203 offset:10240
    v_mfma_f32_16x16x32_bf16 v[134:137], v[78:81], v[86:89], v[134:137]
    ds_read_b128 v[110:113], v203 offset:14336
    v_mfma_f32_16x16x32_bf16 v[138:141], v[82:85], v[86:89], v[138:141]
    ds_read_b64_tr_b16 v[122:123], v205 offset:24576
    v_mfma_f32_16x16x32_bf16 v[142:145], v[70:73], v[90:93], v[142:145]
    ds_read_b64_tr_b16 v[124:125], v205 offset:25088
    v_mfma_f32_16x16x32_bf16 v[146:149], v[74:77], v[90:93], v[146:149]
    s_add_u32 m0, s67, 16384
    s_waitcnt vmcnt(11)
    buffer_load_dwordx4 v190, s[20:23], s7 offen lds
    v_mfma_f32_16x16x32_bf16 v[150:153], v[78:81], v[90:93], v[150:153]
    v_mfma_f32_16x16x32_bf16 v[154:157], v[82:85], v[90:93], v[154:157]
    s_waitcnt vmcnt(11)
    buffer_load_dwordx4 v191, s[20:23], s7 offen offset:1024 lds
    v_mfma_f32_16x16x32_bf16 v[158:161], v[94:97], v[70:73], v[158:161]
    v_mfma_f32_16x16x32_bf16 v[162:165], v[94:97], v[74:77], v[162:165]
    s_add_u32 m0, s67, 32768
    s_waitcnt vmcnt(11)
    buffer_load_dwordx4 v192, s[20:23], s7 offen offset:2048 lds
    v_mfma_f32_16x16x32_bf16 v[166:169], v[94:97], v[78:81], v[166:169]
    v_mfma_f32_16x16x32_bf16 v[170:173], v[94:97], v[82:85], v[170:173]
    s_waitcnt vmcnt(11)
    buffer_load_dwordx4 v193, s[20:23], s7 offen offset:3072 lds
    s_waitcnt lgkmcnt(0)
    v_mfma_f32_16x16x32_bf16 v[126:129], v[98:101], v[114:117], v[126:129]
    s_waitcnt vmcnt(11)
    buffer_load_dwordx4 v192, s[20:23], s7 offen lds
    v_mfma_f32_16x16x32_bf16 v[130:133], v[102:105], v[114:117], v[130:133]
    v_mfma_f32_16x16x32_bf16 v[134:137], v[106:109], v[114:117], v[134:137]
    v_mfma_f32_16x16x32_bf16 v[138:141], v[110:113], v[114:117], v[138:141]
    s_waitcnt vmcnt(11)
    buffer_load_dwordx4 v193, s[20:23], s7 offen offset:1024 lds
    v_mfma_f32_16x16x32_bf16 v[142:145], v[98:101], v[118:121], v[142:145]
    v_mfma_f32_16x16x32_bf16 v[146:149], v[102:105], v[118:121], v[146:149]
    s_waitcnt vmcnt(8) lgkmcnt(0)
    s_barrier
    ds_read_b64_tr_b16 v[58:59], v205 offset:32768
    ds_read_b64_tr_b16 v[60:61], v205 offset:33280
    ds_read_b128 v[42:45], v202 offset:34816
    ds_read_b128 v[46:49], v202 offset:38912
    ds_read_b64_tr_b16 v[62:63], v204 offset:2048
    ds_read_b64_tr_b16 v[64:65], v204 offset:2560
    ds_read_b128 v[50:53], v202 offset:43008
    ds_read_b128 v[54:57], v202 offset:47104
    ds_read_b64_tr_b16 v[66:67], v204 offset:0
    ds_read_b64_tr_b16 v[68:69], v204 offset:512
    ds_read_b64_tr_b16 v[86:87], v205 offset:40960
    ds_read_b64_tr_b16 v[88:89], v205 offset:41472
    ds_read_b128 v[70:73], v203 offset:34816
    ds_read_b128 v[74:77], v203 offset:38912
    ds_read_b64_tr_b16 v[90:91], v204 offset:10240
    v_mfma_f32_16x16x32_bf16 v[150:153], v[106:109], v[118:121], v[150:153]
    s_add_u32 m0, s67, 51200
    s_add_u32 s6, s45, 5
    s_and_b32 s6, s6, 7
    s_lshl_b32 s6, s6, 7
    s_mul_i32 s7, s6, 1536
    s_waitcnt vmcnt(11)
    buffer_load_dwordx4 v194, s[8:11], s6 offen lds
    v_mfma_f32_16x16x32_bf16 v[154:157], v[110:113], v[118:121], v[154:157]
    v_mfma_f32_16x16x32_bf16 v[158:161], v[122:125], v[98:101], v[158:161]
    v_mfma_f32_16x16x32_bf16 v[162:165], v[122:125], v[102:105], v[162:165]
    s_waitcnt vmcnt(11)
    buffer_load_dwordx4 v195, s[8:11], s6 offen offset:1024 lds
    v_mfma_f32_16x16x32_bf16 v[166:169], v[122:125], v[106:109], v[166:169]
    v_mfma_f32_16x16x32_bf16 v[170:173], v[122:125], v[110:113], v[170:173]
    s_waitcnt lgkmcnt(5)
    v_mfma_f32_16x16x32_bf16 v[126:129], v[42:45], v[58:61], v[126:129]
    ds_read_b64_tr_b16 v[92:93], v204 offset:10752
    v_mfma_f32_16x16x32_bf16 v[130:133], v[46:49], v[58:61], v[130:133]
    ds_read_b128 v[78:81], v203 offset:43008
    v_mfma_f32_16x16x32_bf16 v[134:137], v[50:53], v[58:61], v[134:137]
    ds_read_b128 v[82:85], v203 offset:47104
    v_mfma_f32_16x16x32_bf16 v[138:141], v[54:57], v[58:61], v[138:141]
    ds_read_b64_tr_b16 v[94:95], v204 offset:8192
    v_mfma_f32_16x16x32_bf16 v[142:145], v[42:45], v[62:65], v[142:145]
    ds_read_b64_tr_b16 v[96:97], v204 offset:8704
    v_mfma_f32_16x16x32_bf16 v[146:149], v[46:49], v[62:65], v[146:149]
    s_add_u32 m0, s67, 49152
    s_waitcnt vmcnt(11)
    buffer_load_dwordx4 v190, s[20:23], s7 offen lds
    v_mfma_f32_16x16x32_bf16 v[150:153], v[50:53], v[62:65], v[150:153]
    v_mfma_f32_16x16x32_bf16 v[154:157], v[54:57], v[62:65], v[154:157]
    s_waitcnt vmcnt(11)
    buffer_load_dwordx4 v191, s[20:23], s7 offen offset:1024 lds
    v_mfma_f32_16x16x32_bf16 v[158:161], v[66:69], v[42:45], v[158:161]
    v_mfma_f32_16x16x32_bf16 v[162:165], v[66:69], v[46:49], v[162:165]
    s_add_u32 m0, s67, 65536
    s_waitcnt vmcnt(11)
    buffer_load_dwordx4 v192, s[20:23], s7 offen offset:2048 lds
    v_mfma_f32_16x16x32_bf16 v[166:169], v[66:69], v[50:53], v[166:169]
    v_mfma_f32_16x16x32_bf16 v[170:173], v[66:69], v[54:57], v[170:173]
    s_waitcnt vmcnt(11)
    buffer_load_dwordx4 v193, s[20:23], s7 offen offset:3072 lds
    s_waitcnt lgkmcnt(0)
    v_mfma_f32_16x16x32_bf16 v[126:129], v[70:73], v[86:89], v[126:129]
    s_waitcnt vmcnt(11)
    buffer_load_dwordx4 v192, s[20:23], s7 offen lds
    v_mfma_f32_16x16x32_bf16 v[130:133], v[74:77], v[86:89], v[130:133]
    v_mfma_f32_16x16x32_bf16 v[134:137], v[78:81], v[86:89], v[134:137]
    v_mfma_f32_16x16x32_bf16 v[138:141], v[82:85], v[86:89], v[138:141]
    s_waitcnt vmcnt(11)
    buffer_load_dwordx4 v193, s[20:23], s7 offen offset:1024 lds
    v_mfma_f32_16x16x32_bf16 v[142:145], v[70:73], v[90:93], v[142:145]
    v_mfma_f32_16x16x32_bf16 v[146:149], v[74:77], v[90:93], v[146:149]
    s_waitcnt vmcnt(8) lgkmcnt(0)
    s_barrier
    ds_read_b64_tr_b16 v[114:115], v204 offset:16384
    ds_read_b64_tr_b16 v[116:117], v204 offset:16896
    ds_read_b128 v[98:101], v200 offset:18432
    ds_read_b128 v[102:105], v200 offset:22528
    ds_read_b64_tr_b16 v[118:119], v204 offset:34816
    ds_read_b64_tr_b16 v[120:121], v204 offset:35328
    ds_read_b128 v[106:109], v200 offset:26624
    ds_read_b128 v[110:113], v200 offset:30720
    ds_read_b64_tr_b16 v[122:123], v204 offset:32768
    ds_read_b64_tr_b16 v[124:125], v204 offset:33280
    ds_read_b64_tr_b16 v[58:59], v204 offset:24576
    ds_read_b64_tr_b16 v[60:61], v204 offset:25088
    ds_read_b128 v[42:45], v201 offset:18432
    ds_read_b128 v[46:49], v201 offset:22528
    ds_read_b64_tr_b16 v[62:63], v204 offset:43008
    v_mfma_f32_16x16x32_bf16 v[150:153], v[78:81], v[90:93], v[150:153]
    s_add_u32 m0, s67, 83968
    s_add_u32 s6, s45, 6
    s_and_b32 s6, s6, 7
    s_lshl_b32 s6, s6, 7
    s_mul_i32 s7, s6, 1536
    s_waitcnt vmcnt(11)
    buffer_load_dwordx4 v194, s[8:11], s6 offen lds
    v_mfma_f32_16x16x32_bf16 v[154:157], v[82:85], v[90:93], v[154:157]
    v_mfma_f32_16x16x32_bf16 v[158:161], v[94:97], v[70:73], v[158:161]
    v_mfma_f32_16x16x32_bf16 v[162:165], v[94:97], v[74:77], v[162:165]
    s_waitcnt vmcnt(11)
    buffer_load_dwordx4 v195, s[8:11], s6 offen offset:1024 lds
    v_mfma_f32_16x16x32_bf16 v[166:169], v[94:97], v[78:81], v[166:169]
    v_mfma_f32_16x16x32_bf16 v[170:173], v[94:97], v[82:85], v[170:173]
    s_waitcnt lgkmcnt(5)
    v_mfma_f32_16x16x32_bf16 v[126:129], v[98:101], v[114:117], v[126:129]
    ds_read_b64_tr_b16 v[64:65], v204 offset:43520
    v_mfma_f32_16x16x32_bf16 v[130:133], v[102:105], v[114:117], v[130:133]
    ds_read_b128 v[50:53], v201 offset:26624
    v_mfma_f32_16x16x32_bf16 v[134:137], v[106:109], v[114:117], v[134:137]
    ds_read_b128 v[54:57], v201 offset:30720
    v_mfma_f32_16x16x32_bf16 v[138:141], v[110:113], v[114:117], v[138:141]
    ds_read_b64_tr_b16 v[66:67], v204 offset:40960
    v_mfma_f32_16x16x32_bf16 v[142:145], v[98:101], v[118:121], v[142:145]
    ds_read_b64_tr_b16 v[68:69], v204 offset:41472
    v_mfma_f32_16x16x32_bf16 v[146:149], v[102:105], v[118:121], v[146:149]
    s_add_u32 m0, s67, 81920
    s_waitcnt vmcnt(11)
    buffer_load_dwordx4 v190, s[20:23], s7 offen lds
    v_mfma_f32_16x16x32_bf16 v[150:153], v[106:109], v[118:121], v[150:153]
    v_mfma_f32_16x16x32_bf16 v[154:157], v[110:113], v[118:121], v[154:157]
    s_waitcnt vmcnt(11)
    buffer_load_dwordx4 v191, s[20:23], s7 offen offset:1024 lds
    v_mfma_f32_16x16x32_bf16 v[158:161], v[122:125], v[98:101], v[158:161]
    v_mfma_f32_16x16x32_bf16 v[162:165], v[122:125], v[102:105], v[162:165]
    s_add_u32 m0, s67, 98304
    s_waitcnt vmcnt(11)
    buffer_load_dwordx4 v192, s[20:23], s7 offen offset:2048 lds
    v_mfma_f32_16x16x32_bf16 v[166:169], v[122:125], v[106:109], v[166:169]
    v_mfma_f32_16x16x32_bf16 v[170:173], v[122:125], v[110:113], v[170:173]
    s_waitcnt vmcnt(11)
    buffer_load_dwordx4 v193, s[20:23], s7 offen offset:3072 lds
    s_waitcnt lgkmcnt(0)
    v_mfma_f32_16x16x32_bf16 v[126:129], v[42:45], v[58:61], v[126:129]
    s_waitcnt vmcnt(11)
    buffer_load_dwordx4 v192, s[20:23], s7 offen lds
    v_mfma_f32_16x16x32_bf16 v[130:133], v[46:49], v[58:61], v[130:133]
    v_mfma_f32_16x16x32_bf16 v[134:137], v[50:53], v[58:61], v[134:137]
    v_mfma_f32_16x16x32_bf16 v[138:141], v[54:57], v[58:61], v[138:141]
    s_waitcnt vmcnt(11)
    buffer_load_dwordx4 v193, s[20:23], s7 offen offset:1024 lds
    v_mfma_f32_16x16x32_bf16 v[142:145], v[42:45], v[62:65], v[142:145]
    v_mfma_f32_16x16x32_bf16 v[146:149], v[46:49], v[62:65], v[146:149]
    s_waitcnt vmcnt(8) lgkmcnt(0)
    s_barrier
    ds_read_b64_tr_b16 v[86:87], v204 offset:49152
    ds_read_b64_tr_b16 v[88:89], v204 offset:49664
    ds_read_b128 v[70:73], v200 offset:51200
    ds_read_b128 v[74:77], v200 offset:55296
    ds_read_b64_tr_b16 v[90:91], v205 offset:2048
    ds_read_b64_tr_b16 v[92:93], v205 offset:2560
    ds_read_b128 v[78:81], v200 offset:59392
    ds_read_b128 v[82:85], v200 offset:63488
    ds_read_b64_tr_b16 v[94:95], v205 offset:0
    ds_read_b64_tr_b16 v[96:97], v205 offset:512
    ds_read_b64_tr_b16 v[114:115], v204 offset:57344
    ds_read_b64_tr_b16 v[116:117], v204 offset:57856
    ds_read_b128 v[98:101], v201 offset:51200
    ds_read_b128 v[102:105], v201 offset:55296
    ds_read_b64_tr_b16 v[118:119], v205 offset:10240
    v_mfma_f32_16x16x32_bf16 v[150:153], v[50:53], v[62:65], v[150:153]
    s_add_u32 m0, s67, 2048
    s_add_u32 s6, s45, 7
    s_and_b32 s6, s6, 7
    s_lshl_b32 s6, s6, 7
    s_mul_i32 s7, s6, 1536
    s_waitcnt vmcnt(11)
    buffer_load_dwordx4 v194, s[8:11], s6 offen lds
    v_mfma_f32_16x16x32_bf16 v[154:157], v[54:57], v[62:65], v[154:157]
    v_mfma_f32_16x16x32_bf16 v[158:161], v[66:69], v[42:45], v[158:161]
    v_mfma_f32_16x16x32_bf16 v[162:165], v[66:69], v[46:49], v[162:165]
    s_waitcnt vmcnt(11)
    buffer_load_dwordx4 v195, s[8:11], s6 offen offset:1024 lds
    v_mfma_f32_16x16x32_bf16 v[166:169], v[66:69], v[50:53], v[166:169]
    v_mfma_f32_16x16x32_bf16 v[170:173], v[66:69], v[54:57], v[170:173]
    s_waitcnt lgkmcnt(5)
    v_mfma_f32_16x16x32_bf16 v[126:129], v[70:73], v[86:89], v[126:129]
    ds_read_b64_tr_b16 v[120:121], v205 offset:10752
    v_mfma_f32_16x16x32_bf16 v[130:133], v[74:77], v[86:89], v[130:133]
    ds_read_b128 v[106:109], v201 offset:59392
    v_mfma_f32_16x16x32_bf16 v[134:137], v[78:81], v[86:89], v[134:137]
    ds_read_b128 v[110:113], v201 offset:63488
    v_mfma_f32_16x16x32_bf16 v[138:141], v[82:85], v[86:89], v[138:141]
    ds_read_b64_tr_b16 v[122:123], v205 offset:8192
    v_mfma_f32_16x16x32_bf16 v[142:145], v[70:73], v[90:93], v[142:145]
    ds_read_b64_tr_b16 v[124:125], v205 offset:8704
    v_mfma_f32_16x16x32_bf16 v[146:149], v[74:77], v[90:93], v[146:149]
    s_add_u32 m0, s67, 0
    s_waitcnt vmcnt(11)
    buffer_load_dwordx4 v190, s[20:23], s7 offen lds
    v_mfma_f32_16x16x32_bf16 v[150:153], v[78:81], v[90:93], v[150:153]
    v_mfma_f32_16x16x32_bf16 v[154:157], v[82:85], v[90:93], v[154:157]
    s_waitcnt vmcnt(11)
    buffer_load_dwordx4 v191, s[20:23], s7 offen offset:1024 lds
    v_mfma_f32_16x16x32_bf16 v[158:161], v[94:97], v[70:73], v[158:161]
    v_mfma_f32_16x16x32_bf16 v[162:165], v[94:97], v[74:77], v[162:165]
    s_add_u32 m0, s67, 16384
    s_waitcnt vmcnt(11)
    buffer_load_dwordx4 v192, s[20:23], s7 offen offset:2048 lds
    v_mfma_f32_16x16x32_bf16 v[166:169], v[94:97], v[78:81], v[166:169]
    v_mfma_f32_16x16x32_bf16 v[170:173], v[94:97], v[82:85], v[170:173]
    s_waitcnt vmcnt(11)
    buffer_load_dwordx4 v193, s[20:23], s7 offen offset:3072 lds
    s_waitcnt lgkmcnt(0)
    v_mfma_f32_16x16x32_bf16 v[126:129], v[98:101], v[114:117], v[126:129]
    s_waitcnt vmcnt(11)
    buffer_load_dwordx4 v192, s[20:23], s7 offen lds
    v_mfma_f32_16x16x32_bf16 v[130:133], v[102:105], v[114:117], v[130:133]
    v_mfma_f32_16x16x32_bf16 v[134:137], v[106:109], v[114:117], v[134:137]
    v_mfma_f32_16x16x32_bf16 v[138:141], v[110:113], v[114:117], v[138:141]
    s_waitcnt vmcnt(11)
    buffer_load_dwordx4 v193, s[20:23], s7 offen offset:1024 lds
    v_mfma_f32_16x16x32_bf16 v[142:145], v[98:101], v[118:121], v[142:145]
    v_mfma_f32_16x16x32_bf16 v[146:149], v[102:105], v[118:121], v[146:149]
    s_waitcnt vmcnt(8) lgkmcnt(0)
    s_barrier
    ds_read_b64_tr_b16 v[58:59], v205 offset:16384
    ds_read_b64_tr_b16 v[60:61], v205 offset:16896
    ds_read_b128 v[42:45], v202 offset:18432
    ds_read_b128 v[46:49], v202 offset:22528
    ds_read_b64_tr_b16 v[62:63], v205 offset:34816
    ds_read_b64_tr_b16 v[64:65], v205 offset:35328
    ds_read_b128 v[50:53], v202 offset:26624
    ds_read_b128 v[54:57], v202 offset:30720
    ds_read_b64_tr_b16 v[66:67], v205 offset:32768
    ds_read_b64_tr_b16 v[68:69], v205 offset:33280
    ds_read_b64_tr_b16 v[86:87], v205 offset:24576
    ds_read_b64_tr_b16 v[88:89], v205 offset:25088
    ds_read_b128 v[70:73], v203 offset:18432
    ds_read_b128 v[74:77], v203 offset:22528
    ds_read_b64_tr_b16 v[90:91], v205 offset:43008
    v_mfma_f32_16x16x32_bf16 v[150:153], v[106:109], v[118:121], v[150:153]
    v_mfma_f32_16x16x32_bf16 v[154:157], v[110:113], v[118:121], v[154:157]
    v_mfma_f32_16x16x32_bf16 v[158:161], v[122:125], v[98:101], v[158:161]
    v_mfma_f32_16x16x32_bf16 v[162:165], v[122:125], v[102:105], v[162:165]
    v_mfma_f32_16x16x32_bf16 v[166:169], v[122:125], v[106:109], v[166:169]
    v_mfma_f32_16x16x32_bf16 v[170:173], v[122:125], v[110:113], v[170:173]
    s_waitcnt lgkmcnt(5)
    v_mfma_f32_16x16x32_bf16 v[126:129], v[42:45], v[58:61], v[126:129]
    ds_read_b64_tr_b16 v[92:93], v205 offset:43520
    v_mfma_f32_16x16x32_bf16 v[130:133], v[46:49], v[58:61], v[130:133]
    ds_read_b128 v[78:81], v203 offset:26624
    v_mfma_f32_16x16x32_bf16 v[134:137], v[50:53], v[58:61], v[134:137]
    ds_read_b128 v[82:85], v203 offset:30720
    v_mfma_f32_16x16x32_bf16 v[138:141], v[54:57], v[58:61], v[138:141]
    ds_read_b64_tr_b16 v[94:95], v205 offset:40960
    v_mfma_f32_16x16x32_bf16 v[142:145], v[42:45], v[62:65], v[142:145]
    ds_read_b64_tr_b16 v[96:97], v205 offset:41472
    v_mfma_f32_16x16x32_bf16 v[146:149], v[46:49], v[62:65], v[146:149]
    v_mfma_f32_16x16x32_bf16 v[150:153], v[50:53], v[62:65], v[150:153]
    v_mfma_f32_16x16x32_bf16 v[154:157], v[54:57], v[62:65], v[154:157]
    v_mfma_f32_16x16x32_bf16 v[158:161], v[66:69], v[42:45], v[158:161]
    v_mfma_f32_16x16x32_bf16 v[162:165], v[66:69], v[46:49], v[162:165]
    v_mfma_f32_16x16x32_bf16 v[166:169], v[66:69], v[50:53], v[166:169]
    v_mfma_f32_16x16x32_bf16 v[170:173], v[66:69], v[54:57], v[170:173]
    s_waitcnt lgkmcnt(0)
    v_mfma_f32_16x16x32_bf16 v[126:129], v[70:73], v[86:89], v[126:129]
    v_mfma_f32_16x16x32_bf16 v[130:133], v[74:77], v[86:89], v[130:133]
    v_mfma_f32_16x16x32_bf16 v[134:137], v[78:81], v[86:89], v[134:137]
    v_mfma_f32_16x16x32_bf16 v[138:141], v[82:85], v[86:89], v[138:141]
    v_mfma_f32_16x16x32_bf16 v[142:145], v[70:73], v[90:93], v[142:145]
    v_mfma_f32_16x16x32_bf16 v[146:149], v[74:77], v[90:93], v[146:149]
    s_waitcnt vmcnt(4) lgkmcnt(0)
    s_barrier
    s_setprio 1
    ds_read_b64_tr_b16 v[114:115], v204 offset:0
    ds_read_b64_tr_b16 v[116:117], v204 offset:512
    ds_read_b128 v[98:101], v200 offset:2048
    ds_read_b128 v[102:105], v200 offset:6144
    ds_read_b128 v[106:109], v200 offset:10240
    ds_read_b128 v[110:113], v200 offset:14336
    ds_read_b64_tr_b16 v[58:59], v204 offset:8192
    ds_read_b64_tr_b16 v[60:61], v204 offset:8704
    ds_read_b128 v[42:45], v201 offset:2048
    ds_read_b128 v[46:49], v201 offset:6144
    ds_read_b128 v[50:53], v201 offset:10240
    ds_read_b128 v[54:57], v201 offset:14336
    v_mfma_f32_16x16x32_bf16 v[150:153], v[78:81], v[90:93], v[150:153]
    v_mfma_f32_16x16x32_bf16 v[154:157], v[82:85], v[90:93], v[154:157]
    v_mfma_f32_16x16x32_bf16 v[158:161], v[94:97], v[70:73], v[158:161]
    v_mfma_f32_16x16x32_bf16 v[162:165], v[94:97], v[74:77], v[162:165]
    v_mfma_f32_16x16x32_bf16 v[166:169], v[94:97], v[78:81], v[166:169]
    v_mfma_f32_16x16x32_bf16 v[170:173], v[94:97], v[82:85], v[170:173]
    s_waitcnt lgkmcnt(6)
    v_mfma_f32_16x16x32_bf16 v[126:129], v[98:101], v[114:117], v[126:129]
    v_mfma_f32_16x16x32_bf16 v[130:133], v[102:105], v[114:117], v[130:133]
    v_mfma_f32_16x16x32_bf16 v[134:137], v[106:109], v[114:117], v[134:137]
    v_mfma_f32_16x16x32_bf16 v[138:141], v[110:113], v[114:117], v[138:141]
    s_waitcnt lgkmcnt(0)
    v_mfma_f32_16x16x32_bf16 v[126:129], v[42:45], v[58:61], v[126:129]
    v_mfma_f32_16x16x32_bf16 v[130:133], v[46:49], v[58:61], v[130:133]
    v_mfma_f32_16x16x32_bf16 v[134:137], v[50:53], v[58:61], v[134:137]
    v_mfma_f32_16x16x32_bf16 v[138:141], v[54:57], v[58:61], v[138:141]
    s_waitcnt vmcnt(0)
    s_barrier
    ds_read_b64_tr_b16 v[118:119], v204 offset:18432
    ds_read_b64_tr_b16 v[120:121], v204 offset:18944
    ds_read_b64_tr_b16 v[62:63], v204 offset:26624
    ds_read_b64_tr_b16 v[64:65], v204 offset:27136
    ds_read_b64_tr_b16 v[122:123], v204 offset:16384
    ds_read_b64_tr_b16 v[124:125], v204 offset:16896
    ds_read_b64_tr_b16 v[66:67], v204 offset:24576
    ds_read_b64_tr_b16 v[68:69], v204 offset:25088
    ds_read_b128 v[4:7], v3 offset:0
    v_pk_mul_f32 v[174:175], v[126:127], s[60:61]
    v_pk_mul_f32 v[176:177], v[128:129], s[60:61]
    v_pk_mul_f32 v[178:179], v[130:131], s[60:61]
    v_pk_mul_f32 v[180:181], v[132:133], s[60:61]
    v_pk_mul_f32 v[182:183], v[134:135], s[60:61]
    s_add_u32 m0, s62, 151296
    s_add_u32 s53, s55, 0
    s_and_b32 s53, s53, 7
    s_or_b32 s53, s53, 8
    s_lshl_b32 s53, s53, 15
    s_add_u32 s53, s53, s54
    buffer_load_dwordx4 v222, s[24:27], s53 offen lds
    v_pk_mul_f32 v[184:185], v[136:137], s[60:61]
    v_pk_mul_f32 v[186:187], v[138:139], s[60:61]
    v_pk_mul_f32 v[188:189], v[140:141], s[60:61]
    v_exp_f32_e64 v174, v174 clamp
    v_max_f32 v126, 0x358637bd, v126
    v_exp_f32_e64 v175, v175 clamp
    v_max_f32 v127, 0x358637bd, v127
    v_exp_f32_e64 v176, v176 clamp
    s_waitcnt lgkmcnt(0)
    v_max_f32 v128, 0x358637bd, v128
    v_mfma_f32_16x16x32_bf16 v[142:145], v[98:101], v[118:121], v[142:145]
    v_exp_f32_e64 v177, v177 clamp
    v_max_f32 v129, 0x358637bd, v129
    v_mfma_f32_16x16x32_bf16 v[146:149], v[102:105], v[118:121], v[146:149]
    v_exp_f32_e64 v178, v178 clamp
    v_max_f32 v130, 0x358637bd, v130
    v_mfma_f32_16x16x32_bf16 v[150:153], v[106:109], v[118:121], v[150:153]
    v_exp_f32_e64 v179, v179 clamp
    buffer_load_dwordx4 v223, s[24:27], s53 offen offset:1024 lds
    v_max_f32 v131, 0x358637bd, v131
    v_mfma_f32_16x16x32_bf16 v[154:157], v[110:113], v[118:121], v[154:157]
    v_exp_f32_e64 v180, v180 clamp
    v_max_f32 v132, 0x358637bd, v132
    v_mfma_f32_16x16x32_bf16 v[142:145], v[42:45], v[62:65], v[142:145]
    v_exp_f32_e64 v181, v181 clamp
    v_max_f32 v133, 0x358637bd, v133
    v_mfma_f32_16x16x32_bf16 v[146:149], v[46:49], v[62:65], v[146:149]
    v_exp_f32_e64 v182, v182 clamp
    v_max_f32 v134, 0x358637bd, v134
    v_mfma_f32_16x16x32_bf16 v[150:153], v[50:53], v[62:65], v[150:153]
    v_exp_f32_e64 v183, v183 clamp
    v_max_f32 v135, 0x358637bd, v135
    v_mfma_f32_16x16x32_bf16 v[154:157], v[54:57], v[62:65], v[154:157]
    v_exp_f32_e64 v184, v184 clamp
    v_max_f32 v136, 0x358637bd, v136
    v_mfma_f32_16x16x32_bf16 v[158:161], v[122:125], v[98:101], v[158:161]
    v_exp_f32_e64 v185, v185 clamp
    v_max_f32 v137, 0x358637bd, v137
    v_mfma_f32_16x16x32_bf16 v[162:165], v[122:125], v[102:105], v[162:165]
    v_exp_f32_e64 v186, v186 clamp
    s_add_u32 m0, s62, 142080
    s_add_u32 s53, s55, 0
    s_and_b32 s53, s53, 7
    s_lshl_b32 s53, s53, 15
    s_add_u32 s53, s53, s54
    buffer_load_dwordx4 v222, s[24:27], s53 offen lds
    v_max_f32 v138, 0x358637bd, v138
    v_mfma_f32_16x16x32_bf16 v[166:169], v[122:125], v[106:109], v[166:169]
    v_exp_f32_e64 v187, v187 clamp
    v_max_f32 v139, 0x358637bd, v139
    v_mfma_f32_16x16x32_bf16 v[170:173], v[122:125], v[110:113], v[170:173]
    v_exp_f32_e64 v188, v188 clamp
    v_max_f32 v140, 0x358637bd, v140
    v_mfma_f32_16x16x32_bf16 v[158:161], v[66:69], v[42:45], v[158:161]
    v_exp_f32_e64 v189, v189 clamp
    v_max_f32 v141, 0x358637bd, v141
    v_mfma_f32_16x16x32_bf16 v[162:165], v[66:69], v[46:49], v[162:165]
    v_pk_add_f32 v[174:175], v[174:175], v[126:127]
    v_pk_add_f32 v[176:177], v[176:177], v[128:129]
    v_mfma_f32_16x16x32_bf16 v[166:169], v[66:69], v[50:53], v[166:169]
    v_pk_add_f32 v[178:179], v[178:179], v[130:131]
    v_pk_add_f32 v[180:181], v[180:181], v[132:133]
    v_mfma_f32_16x16x32_bf16 v[170:173], v[66:69], v[54:57], v[170:173]
    v_pk_add_f32 v[182:183], v[182:183], v[134:135]
    v_pk_add_f32 v[184:185], v[184:185], v[136:137]
    v_pk_add_f32 v[186:187], v[186:187], v[138:139]
    buffer_load_dwordx4 v223, s[24:27], s53 offen offset:1024 lds
    v_pk_add_f32 v[188:189], v[188:189], v[140:141]
    v_cvt_pk_bf16_f32 v126, v174, v175
    v_cvt_pk_bf16_f32 v127, v176, v177
    v_cvt_pk_bf16_f32 v128, v178, v179
    v_cvt_pk_bf16_f32 v129, v180, v181
    v_cvt_pk_bf16_f32 v130, v182, v183
    v_cvt_pk_bf16_f32 v131, v184, v185
    v_cvt_pk_bf16_f32 v132, v186, v187
    v_cvt_pk_bf16_f32 v133, v188, v189
    v_cvt_pk_bf16_f32 v134, v142, v143
    v_cvt_pk_bf16_f32 v135, v144, v145
    v_cvt_pk_bf16_f32 v136, v146, v147
    v_cvt_pk_bf16_f32 v137, v148, v149
    v_cvt_pk_bf16_f32 v138, v150, v151
    v_cvt_pk_bf16_f32 v139, v152, v153
    v_cvt_pk_bf16_f32 v140, v154, v155
    v_cvt_pk_bf16_f32 v141, v156, v157
    v_mfma_f32_16x16x32_bf16 v[142:145], v[126:129], v[134:137], 0
    v_mfma_f32_16x16x32_bf16 v[146:149], v[126:129], v[212:215], v[218:221]
    v_mfma_f32_16x16x32_bf16 v[142:145], v[130:133], v[138:141], v[142:145]
    v_mfma_f32_16x16x32_bf16 v[146:149], v[130:133], v[212:215], v[146:149]
sw_20:
    s_waitcnt lgkmcnt(0)
    v_min3_u32 v4, v4, v5, v6
    v_min_u32 v4, v4, v7
    s_nop 0
    v_readfirstlane_b32 s57, v4
    s_nop 1
    s_cmp_ge_u32 s57, 3
    s_cbranch_scc1 sd_21
    ds_read_b128 v[4:7], v3 offset:0
    s_branch sw_20
sd_21:
    s_nop 1
    v_cvt_pk_bf16_f32 v150, v142, v143
    v_cvt_pk_bf16_f32 v151, v144, v145
    v_cvt_pk_bf16_f32 v152, v146, v147
    v_cvt_pk_bf16_f32 v153, v148, v149
    v_permlane16_swap_b32 v150, v151
    s_nop 0
    v_permlane16_swap_b32 v152, v153
    buffer_atomic_pk_add_bf16 v150, v208, s[36:39], s50 offen
    buffer_atomic_pk_add_bf16 v151, v208, s[36:39], s50 offen offset:512
    s_mov_b32 exec_lo, 0x00010001
    s_mov_b32 exec_hi, 0x00010001
    buffer_atomic_pk_add_bf16 v152, v208, s[36:39], s50 offen offset:256
    buffer_atomic_pk_add_bf16 v153, v208, s[36:39], s50 offen offset:768
    s_mov_b64 exec, -1
    v_mov_b32 v8, 11
    ds_write_b32 v2, v8
    v_pk_mul_f32 v[174:175], v[158:159], s[60:61]
    v_pk_mul_f32 v[176:177], v[160:161], s[60:61]
    v_pk_mul_f32 v[178:179], v[162:163], s[60:61]
    v_pk_mul_f32 v[180:181], v[164:165], s[60:61]
    v_pk_mul_f32 v[182:183], v[166:167], s[60:61]
    v_pk_mul_f32 v[184:185], v[168:169], s[60:61]
    v_pk_mul_f32 v[186:187], v[170:171], s[60:61]
    v_pk_mul_f32 v[188:189], v[172:173], s[60:61]
    v_exp_f32_e64 v174, v174 clamp
    v_max_f32 v158, 0x358637bd, v158
    v_exp_f32_e64 v175, v175 clamp
    v_max_f32 v159, 0x358637bd, v159
    v_exp_f32_e64 v176, v176 clamp
    v_max_f32 v160, 0x358637bd, v160
    v_exp_f32_e64 v177, v177 clamp
    v_max_f32 v161, 0x358637bd, v161
    v_exp_f32_e64 v178, v178 clamp
    v_max_f32 v162, 0x358637bd, v162
    v_exp_f32_e64 v179, v179 clamp
    v_max_f32 v163, 0x358637bd, v163
    v_exp_f32_e64 v180, v180 clamp
    v_max_f32 v164, 0x358637bd, v164
    v_exp_f32_e64 v181, v181 clamp
    v_max_f32 v165, 0x358637bd, v165
    v_exp_f32_e64 v182, v182 clamp
    v_max_f32 v166, 0x358637bd, v166
    v_exp_f32_e64 v183, v183 clamp
    v_max_f32 v167, 0x358637bd, v167
    v_exp_f32_e64 v184, v184 clamp
    v_max_f32 v168, 0x358637bd, v168
    v_exp_f32_e64 v185, v185 clamp
    v_max_f32 v169, 0x358637bd, v169
    v_exp_f32_e64 v186, v186 clamp
    v_max_f32 v170, 0x358637bd, v170
    v_exp_f32_e64 v187, v187 clamp
    v_max_f32 v171, 0x358637bd, v171
    v_exp_f32_e64 v188, v188 clamp
    v_max_f32 v172, 0x358637bd, v172
    v_exp_f32_e64 v189, v189 clamp
    v_max_f32 v173, 0x358637bd, v173
    v_pk_add_f32 v[174:175], v[174:175], v[158:159]
    v_pk_add_f32 v[176:177], v[176:177], v[160:161]
    v_pk_add_f32 v[178:179], v[178:179], v[162:163]
    v_pk_add_f32 v[180:181], v[180:181], v[164:165]
    v_pk_add_f32 v[182:183], v[182:183], v[166:167]
    v_pk_add_f32 v[184:185], v[184:185], v[168:169]
    v_pk_add_f32 v[186:187], v[186:187], v[170:171]
    v_pk_add_f32 v[188:189], v[188:189], v[172:173]
    v_cvt_pk_bf16_f32 v126, v174, v175
    v_cvt_pk_bf16_f32 v127, v176, v177
    v_cvt_pk_bf16_f32 v128, v178, v179
    v_cvt_pk_bf16_f32 v129, v180, v181
    v_cvt_pk_bf16_f32 v130, v182, v183
    v_cvt_pk_bf16_f32 v131, v184, v185
    v_cvt_pk_bf16_f32 v132, v186, v187
    v_cvt_pk_bf16_f32 v133, v188, v189
    v_permlane32_swap_b32 v126, v128
    v_permlane32_swap_b32 v127, v129
    v_permlane32_swap_b32 v130, v132
    v_permlane32_swap_b32 v131, v133
    buffer_store_dwordx4 v[126:129], v209, s[36:39], s52 offen sc1
    s_add_u32 s52, s52, 32768
    buffer_store_dwordx4 v[130:133], v209, s[36:39], s52 offen sc1
    s_setprio 0
    s_add_u32 m0, s62, 32768
    s_add_u32 s53, s55, 1
    s_and_b32 s53, s53, 7
    s_or_b32 s53, s53, 8
    s_lshl_b32 s53, s53, 15
    s_add_u32 s53, s53, s54
    buffer_load_dwordx4 v222, s[24:27], s53 offen lds
    buffer_load_dwordx4 v223, s[24:27], s53 offen offset:1024 lds
    s_add_u32 m0, s62, 40960
    s_add_u32 s53, s55, 2
    s_and_b32 s53, s53, 7
    s_or_b32 s53, s53, 8
    s_lshl_b32 s53, s53, 15
    s_add_u32 s53, s53, s54
    buffer_load_dwordx4 v222, s[24:27], s53 offen lds
    buffer_load_dwordx4 v223, s[24:27], s53 offen offset:1024 lds
    s_add_u32 m0, s62, 49152
    s_add_u32 s53, s55, 3
    s_and_b32 s53, s53, 7
    s_or_b32 s53, s53, 8
    s_lshl_b32 s53, s53, 15
    s_add_u32 s53, s53, s54
    buffer_load_dwordx4 v222, s[24:27], s53 offen lds
    buffer_load_dwordx4 v223, s[24:27], s53 offen offset:1024 lds
    s_add_u32 m0, s62, 57344
    s_add_u32 s53, s55, 4
    s_and_b32 s53, s53, 7
    s_or_b32 s53, s53, 8
    s_lshl_b32 s53, s53, 15
    s_add_u32 s53, s53, s54
    buffer_load_dwordx4 v222, s[24:27], s53 offen lds
    buffer_load_dwordx4 v223, s[24:27], s53 offen offset:1024 lds
    v_mov_b32 v186, 0x45004500
    v_mov_b32 v187, 0x45004500
    v_mov_b32 v188, 0x45004500
    v_mov_b32 v189, 0x45004500
    v_mov_b32 v190, 0x45004500
    v_mov_b32 v191, 0x45004500
    v_mov_b32 v192, 0x45004500
    v_mov_b32 v193, 0x45004500
    v_mov_b32 v194, 0x45004500
    v_mov_b32 v195, 0x45004500
    v_mov_b32 v196, 0x45004500
    v_mov_b32 v197, 0x45004500
    v_mov_b32 v198, 0x45004500
    v_mov_b32 v199, 0x45004500
    v_mov_b32 v200, 0x45004500
    v_mov_b32 v201, 0x45004500
    v_mov_b32 v202, 0x45004500
    v_mov_b32 v203, 0x45004500
    v_mov_b32 v204, 0x45004500
    v_mov_b32 v205, 0x45004500
    v_mov_b32 v206, 0x45004500
    v_mov_b32 v207, 0x45004500
    v_mov_b32 v208, 0x45004500
    v_mov_b32 v209, 0x45004500
    v_mov_b32 v210, 0x45004500
    v_mov_b32 v211, 0x45004500
    v_mov_b32 v212, 0x45004500
    v_mov_b32 v213, 0x45004500
    v_mov_b32 v214, 0x45004500
    v_mov_b32 v215, 0x45004500
    v_mov_b32 v216, 0x45004500
    v_mov_b32 v217, 0x45004500
    s_lshl_b32 s50, s47, 2
    s_and_b32 s52, s50, 8
    s_sub_u32 s50, s50, s55
    s_and_b32 s51, s50, 7
    s_or_b32 s51, s51, s52
    s_lshl_b32 s51, s51, 11
    v_add_u32 v238, s51, v1
    s_add_u32 s50, s50, 1
    s_and_b32 s51, s50, 7
    s_or_b32 s51, s51, s52
    s_lshl_b32 s51, s51, 11
    v_add_u32 v239, s51, v1
    s_add_u32 s50, s50, 1
    s_and_b32 s51, s50, 7
    s_or_b32 s51, s51, s52
    s_lshl_b32 s51, s51, 11
    v_add_u32 v248, s51, v1
    s_add_u32 s50, s50, 1
    s_and_b32 s51, s50, 7
    s_or_b32 s51, s51, s52
    s_lshl_b32 s51, s51, 11
    v_add_u32 v249, s51, v1
    s_add_u32 s50, s14, 4096
    s_add_u32 s51, s13, 4096
    s_waitcnt vmcnt(8)
    s_mov_b64 exec, 1
    v_mov_b32 v8, 1
    ds_add_rtn_u32 v4, v3, v8 offset:32
    s_waitcnt lgkmcnt(0)
    v_readfirstlane_b32 s57, v4
    s_mov_b64 exec, -1
    s_nop 0
    s_cmp_lg_u32 s57, 3
    s_cbranch_scc1 sig_22
    s_lshl_b32 s56, s43, 8
    s_add_u32 s56, s28, s56
    s_addc_u32 s57, s29, 0
    s_mov_b32 s3, 1
    s_atomic_add s3, s[56:57], 32768
    s_atomic_add s3, s[56:57], 34816
    s_atomic_add s3, s[56:57], 36864
    s_atomic_add s3, s[56:57], 38912
    s_atomic_add s3, s[56:57], 40960
    s_atomic_add s3, s[56:57], 43008
    s_atomic_add s3, s[56:57], 45056
    s_atomic_add s3, s[56:57], 47104
sig_22:
    s_add_u32 m0, s62, 65536
    s_add_u32 s53, s55, 5
    s_and_b32 s53, s53, 7
    s_or_b32 s53, s53, 8
    s_lshl_b32 s53, s53, 15
    s_add_u32 s53, s53, s54
    s_waitcnt vmcnt(9)
    buffer_load_dwordx4 v222, s[24:27], s53 offen lds
    s_waitcnt vmcnt(9)
    buffer_load_dwordx4 v223, s[24:27], s53 offen offset:1024 lds
    s_add_u32 m0, s62, 73728
    s_add_u32 s53, s55, 6
    s_and_b32 s53, s53, 7
    s_or_b32 s53, s53, 8
    s_lshl_b32 s53, s53, 15
    s_add_u32 s53, s53, s54
    s_waitcnt vmcnt(9)
    buffer_load_dwordx4 v222, s[24:27], s53 offen lds
    s_waitcnt vmcnt(9)
    buffer_load_dwordx4 v223, s[24:27], s53 offen offset:1024 lds
    s_add_u32 m0, s62, 81920
    s_add_u32 s53, s55, 7
    s_and_b32 s53, s53, 7
    s_or_b32 s53, s53, 8
    s_lshl_b32 s53, s53, 15
    s_add_u32 s53, s53, s54
    s_waitcnt vmcnt(9)
    buffer_load_dwordx4 v222, s[24:27], s53 offen lds
    s_waitcnt vmcnt(9)
    buffer_load_dwordx4 v223, s[24:27], s53 offen offset:1024 lds
    s_add_u32 m0, s62, 90112
    s_add_u32 s53, s55, 1
    s_and_b32 s53, s53, 7
    s_lshl_b32 s53, s53, 15
    s_add_u32 s53, s53, s54
    s_waitcnt vmcnt(9)
    buffer_load_dwordx4 v222, s[24:27], s53 offen lds
    s_waitcnt vmcnt(9)
    buffer_load_dwordx4 v223, s[24:27], s53 offen offset:1024 lds
    s_add_u32 m0, s62, 98304
    s_add_u32 s53, s55, 2
    s_and_b32 s53, s53, 7
    s_lshl_b32 s53, s53, 15
    s_add_u32 s53, s53, s54
    s_waitcnt vmcnt(9)
    buffer_load_dwordx4 v222, s[24:27], s53 offen lds
    s_waitcnt vmcnt(9)
    buffer_load_dwordx4 v223, s[24:27], s53 offen offset:1024 lds
    s_add_u32 m0, s62, 106496
    s_add_u32 s53, s55, 3
    s_and_b32 s53, s53, 7
    s_lshl_b32 s53, s53, 15
    s_add_u32 s53, s53, s54
    s_waitcnt vmcnt(9)
    buffer_load_dwordx4 v222, s[24:27], s53 offen lds
    s_waitcnt vmcnt(9)
    buffer_load_dwordx4 v223, s[24:27], s53 offen offset:1024 lds
    s_waitcnt vmcnt(6)
    v_mov_b32 v8, 13
    ds_write_b32 v2, v8
s2_23:
    ds_read_b128 v[4:7], v3
    ds_read_b128 v[170:173], v3 offset:16
    s_waitcnt lgkmcnt(0)
    v_min3_u32 v4, v4, v5, v6
    v_min3_u32 v170, v170, v171, v172
    v_min_u32 v4, v4, v7
    v_add_u32 v4, 9, v4
    v_min3_u32 v4, v4, v170, v173
    s_nop 0
    v_readfirstlane_b32 s57, v4
    s_nop 1
    s_cmp_lt_u32 s57, 13
    s_cbranch_scc1 s2_23
    s_mov_b32 s63, 0
    s_atomic_add s63, s[30:31], 32768 glc
    s_mov_b32 s52, 0
    s_atomic_add s52, s[30:31], 33024 glc
    v_add_u32 v156, 57344, v240
    v_add_u32 v157, 57344, v241
    v_add_u32 v158, 114688, v240
    v_add_u32 v159, 114688, v241
    s_add_u32 m0, s62, 0
    s_add_u32 s53, s55, 4
    s_and_b32 s53, s53, 7
    s_lshl_b32 s53, s53, 15
    s_add_u32 s53, s53, s54
    s_waitcnt vmcnt(9)
    buffer_load_dwordx4 v222, s[24:27], s53 offen lds
    ds_read_b64_tr_b16 v[74:75], v158 offset:36608
    ds_read_b64_tr_b16 v[76:77], v158 offset:38656
    ds_read_b64_tr_b16 v[78:79], v159 offset:36608
    ds_read_b64_tr_b16 v[80:81], v159 offset:38656
    s_waitcnt vmcnt(9)
    buffer_load_dwordx4 v223, s[24:27], s53 offen offset:1024 lds
    ds_read_b64_tr_b16 v[82:83], v240 offset:32768
    ds_read_b64_tr_b16 v[84:85], v240 offset:34816
    ds_read_b64_tr_b16 v[86:87], v241 offset:32768
    ds_read_b64_tr_b16 v[88:89], v241 offset:34816
    s_add_u32 m0, s62, 8192
    s_add_u32 s53, s55, 5
    s_and_b32 s53, s53, 7
    s_lshl_b32 s53, s53, 15
    s_add_u32 s53, s53, s54
    s_waitcnt vmcnt(9)
    buffer_load_dwordx4 v222, s[24:27], s53 offen lds
    ds_read_b64_tr_b16 v[90:91], v240 offset:40960
    ds_read_b64_tr_b16 v[92:93], v240 offset:43008
    ds_read_b64_tr_b16 v[94:95], v241 offset:40960
    ds_read_b64_tr_b16 v[96:97], v241 offset:43008
    s_waitcnt vmcnt(9)
    buffer_load_dwordx4 v223, s[24:27], s53 offen offset:1024 lds
    ds_read_b64_tr_b16 v[98:99], v240 offset:49152
    ds_read_b64_tr_b16 v[100:101], v240 offset:51200
    ds_read_b64_tr_b16 v[102:103], v241 offset:49152
    ds_read_b64_tr_b16 v[104:105], v241 offset:51200
    s_add_u32 m0, s62, 16384
    s_add_u32 s53, s55, 6
    s_and_b32 s53, s53, 7
    s_lshl_b32 s53, s53, 15
    s_add_u32 s53, s53, s54
    s_waitcnt vmcnt(9)
    buffer_load_dwordx4 v222, s[24:27], s53 offen lds
    ds_read_b64_tr_b16 v[106:107], v156 offset:0
    ds_read_b64_tr_b16 v[108:109], v156 offset:2048
    ds_read_b64_tr_b16 v[110:111], v157 offset:0
    ds_read_b64_tr_b16 v[112:113], v157 offset:2048
    s_waitcnt vmcnt(9)
    buffer_load_dwordx4 v223, s[24:27], s53 offen offset:1024 lds
    ds_read_b64_tr_b16 v[114:115], v156 offset:8192
    ds_read_b64_tr_b16 v[116:117], v156 offset:10240
    ds_read_b64_tr_b16 v[118:119], v157 offset:8192
    ds_read_b64_tr_b16 v[120:121], v157 offset:10240
    s_add_u32 m0, s62, 24576
    s_add_u32 s53, s55, 7
    s_and_b32 s53, s53, 7
    s_lshl_b32 s53, s53, 15
    s_add_u32 s53, s53, s54
    s_waitcnt vmcnt(9)
    buffer_load_dwordx4 v222, s[24:27], s53 offen lds
    ds_read_b64_tr_b16 v[122:123], v156 offset:16384
    ds_read_b64_tr_b16 v[124:125], v156 offset:18432
    ds_read_b64_tr_b16 v[126:127], v157 offset:16384
    ds_read_b64_tr_b16 v[128:129], v157 offset:18432
    s_waitcnt vmcnt(9)
    buffer_load_dwordx4 v223, s[24:27], s53 offen offset:1024 lds
    ds_read_b64_tr_b16 v[130:131], v156 offset:24576
    ds_read_b64_tr_b16 v[132:133], v156 offset:26624
    ds_read_b64_tr_b16 v[134:135], v157 offset:24576
    ds_read_b64_tr_b16 v[136:137], v157 offset:26624
    s_waitcnt lgkmcnt(0)
    v_mov_b32 v8, 14
    ds_write_b32 v2, v8
    s_and_b32 s63, s63, s52
    s_cmp_lg_u32 s63, 32
    s_cbranch_scc0 c_24
    s_mov_b32 s63, 0
    s_atomic_add s63, s[30:31], 32768 glc
    s_mov_b32 s52, 0
    s_atomic_add s52, s[30:31], 33024 glc
    s_waitcnt vmcnt(0)
    v_mov_b32 v8, 15
    ds_write_b32 v2, v8
    s_mov_b32 s66, 0x2000
    s_branch c_27
p_26:
    s_sub_u32 s66, s66, 1
    s_cbranch_scc1 q_28
    s_mov_b32 s63, 0
    s_atomic_add s63, s[30:31], 32768 glc
    s_mov_b32 s52, 0
    s_atomic_add s52, s[30:31], 33024 glc
c_27:
    s_waitcnt lgkmcnt(0)
    s_and_b32 s63, s63, s52
    s_cmp_lg_u32 s63, 32
    s_cbranch_scc1 p_26
q_28:
c_24:
    s_mov_b32 exec_lo, 0x0011ffff
    s_mov_b32 exec_hi, 0x0011ffff
    buffer_load_dwordx4 v[186:189], v253, s[36:39], s14 offen offset:0 sc1
    s_mov_b64 exec, -1
    buffer_load_dwordx4 v[42:45], v1, s[36:39], s13 offen offset:0 sc1
    s_mov_b32 exec_lo, 0x0011ffff
    s_mov_b32 exec_hi, 0x0011ffff
    buffer_load_dwordx4 v[190:193], v253, s[36:39], s14 offen offset:1024 sc1
    s_mov_b64 exec, -1
    buffer_load_dwordx4 v[46:49], v1, s[36:39], s13 offen offset:1024 sc1
    s_mov_b32 exec_lo, 0x0011ffff
    s_mov_b32 exec_hi, 0x0011ffff
    buffer_load_dwordx4 v[194:197], v253, s[36:39], s14 offen offset:2048 sc1
    s_mov_b64 exec, -1
    buffer_load_dwordx4 v[50:53], v1, s[36:39], s13 offen offset:2048 sc1
    s_mov_b32 exec_lo, 0x0011ffff
    s_mov_b32 exec_hi, 0x0011ffff
    buffer_load_dwordx4 v[198:201], v253, s[36:39], s14 offen offset:3072 sc1
    s_mov_b64 exec, -1
    buffer_load_dwordx4 v[54:57], v1, s[36:39], s13 offen offset:3072 sc1
    s_mov_b32 exec_lo, 0x0011ffff
    s_mov_b32 exec_hi, 0x0011ffff
    buffer_load_dwordx4 v[202:205], v253, s[36:39], s50 offen offset:0 sc1
    s_mov_b64 exec, -1
    buffer_load_dwordx4 v[58:61], v1, s[36:39], s51 offen offset:0 sc1
    s_mov_b32 exec_lo, 0x0011ffff
    s_mov_b32 exec_hi, 0x0011ffff
    buffer_load_dwordx4 v[206:209], v253, s[36:39], s50 offen offset:1024 sc1
    s_mov_b64 exec, -1
    buffer_load_dwordx4 v[62:65], v1, s[36:39], s51 offen offset:1024 sc1
    s_waitcnt vmcnt(12)
    v_mov_b32 v8, 15
    ds_write_b32 v2, v8
s2_29:
    ds_read_b128 v[4:7], v3
    ds_read_b128 v[170:173], v3 offset:16
    s_waitcnt lgkmcnt(0)
    v_min3_u32 v4, v4, v5, v6
    v_min3_u32 v170, v170, v171, v172
    v_min_u32 v4, v4, v7
    v_add_u32 v4, 6, v4
    v_min3_u32 v4, v4, v170, v173
    s_nop 0
    v_readfirstlane_b32 s57, v4
    s_nop 1
    s_cmp_lt_u32 s57, 14
    s_cbranch_scc1 s2_29
    ds_read_b32 v244, v244
    s_waitcnt lgkmcnt(0)
    v_sub_f32 v244, 1.0, v244
    v_cvt_pk_bf16_f32 v244, v244, v244
    v_and_b32 v244, 0xffff0000, v244
    s_waitcnt vmcnt(10)
    v_mfma_f32_32x32x16_bf16 v[138:153], v[186:189], v[42:45], 0
    s_mov_b32 exec_lo, 0x0011ffff
    s_mov_b32 exec_hi, 0x0011ffff
    buffer_load_dwordx4 v[210:213], v253, s[36:39], s50 offen offset:2048 sc1
    s_mov_b64 exec, -1
    buffer_load_dwordx4 v[66:69], v1, s[36:39], s51 offen offset:2048 sc1
    s_waitcnt vmcnt(10)
    v_mfma_f32_32x32x16_bf16 v[154:169], v[190:193], v[46:49], 0
    s_mov_b32 exec_lo, 0x0011ffff
    s_mov_b32 exec_hi, 0x0011ffff
    buffer_load_dwordx4 v[214:217], v253, s[36:39], s50 offen offset:3072 sc1
    s_mov_b64 exec, -1
    buffer_load_dwordx4 v[70:73], v1, s[36:39], s51 offen offset:3072 sc1
    v_add_f32 v146, v146, v147
    v_add_f32 v242, 0x358637bd, v146
    v_rcp_f32 v242, v242
    s_nop 0
    v_mul_f32 v236, v242, v244
    v_mul_f32 v237, v242, v244
    v_pk_mul_f32 v[138:139], v[138:139], v[236:237]
    v_pk_mul_f32 v[140:141], v[140:141], v[236:237]
    v_pk_mul_f32 v[142:143], v[142:143], v[236:237]
    v_pk_mul_f32 v[144:145], v[144:145], v[236:237]
    v_cvt_pk_bf16_f32 v170, v138, v139
    v_cvt_pk_bf16_f32 v171, v140, v141
    v_cvt_pk_bf16_f32 v172, v142, v143
    v_cvt_pk_bf16_f32 v173, v144, v145
    ds_write_b128 v238, v[170:173] offset:32768
    s_waitcnt vmcnt(10)
    v_mfma_f32_32x32x16_bf16 v[138:153], v[194:197], v[50:53], 0
    v_add_f32 v162, v162, v163
    v_add_f32 v242, 0x358637bd, v162
    v_rcp_f32 v242, v242
    s_nop 0
    v_mul_f32 v236, v242, v244
    v_mul_f32 v237, v242, v244
    v_pk_mul_f32 v[154:155], v[154:155], v[236:237]
    v_pk_mul_f32 v[156:157], v[156:157], v[236:237]
    v_pk_mul_f32 v[158:159], v[158:159], v[236:237]
    v_pk_mul_f32 v[160:161], v[160:161], v[236:237]
    v_cvt_pk_bf16_f32 v174, v154, v155
    v_cvt_pk_bf16_f32 v175, v156, v157
    v_cvt_pk_bf16_f32 v176, v158, v159
    v_cvt_pk_bf16_f32 v177, v160, v161
    ds_write_b128 v238, v[174:177] offset:33792
    s_waitcnt vmcnt(8)
    v_mfma_f32_32x32x16_bf16 v[154:169], v[198:201], v[54:57], 0
    v_add_f32 v146, v146, v147
    v_add_f32 v242, 0x358637bd, v146
    v_rcp_f32 v242, v242
    s_nop 0
    v_mul_f32 v236, v242, v244
    v_mul_f32 v237, v242, v244
    v_pk_mul_f32 v[138:139], v[138:139], v[236:237]
    v_pk_mul_f32 v[140:141], v[140:141], v[236:237]
    v_pk_mul_f32 v[142:143], v[142:143], v[236:237]
    v_pk_mul_f32 v[144:145], v[144:145], v[236:237]
    v_cvt_pk_bf16_f32 v178, v138, v139
    v_cvt_pk_bf16_f32 v179, v140, v141
    v_cvt_pk_bf16_f32 v180, v142, v143
    v_cvt_pk_bf16_f32 v181, v144, v145
    ds_write_b128 v239, v[178:181] offset:32768
    s_waitcnt vmcnt(6)
    v_mfma_f32_32x32x16_bf16 v[138:153], v[202:205], v[58:61], 0
    v_add_f32 v162, v162, v163
    v_add_f32 v242, 0x358637bd, v162
    v_rcp_f32 v242, v242
    s_nop 0
    v_mul_f32 v236, v242, v244
    v_mul_f32 v237, v242, v244
    v_pk_mul_f32 v[154:155], v[154:155], v[236:237]
    v_pk_mul_f32 v[156:157], v[156:157], v[236:237]
    v_pk_mul_f32 v[158:159], v[158:159], v[236:237]
    v_pk_mul_f32 v[160:161], v[160:161], v[236:237]
    v_cvt_pk_bf16_f32 v182, v154, v155
    v_cvt_pk_bf16_f32 v183, v156, v157
    v_cvt_pk_bf16_f32 v184, v158, v159
    v_cvt_pk_bf16_f32 v185, v160, v161
    ds_write_b128 v239, v[182:185] offset:33792
    s_waitcnt vmcnt(4)
    v_mfma_f32_32x32x16_bf16 v[154:169], v[206:209], v[62:65], 0
    v_add_f32 v146, v146, v147
    v_add_f32 v242, 0x358637bd, v146
    v_rcp_f32 v242, v242
    s_nop 0
    v_mul_f32 v236, v242, v244
    v_mul_f32 v237, v242, v244
    v_pk_mul_f32 v[138:139], v[138:139], v[236:237]
    v_pk_mul_f32 v[140:141], v[140:141], v[236:237]
    v_pk_mul_f32 v[142:143], v[142:143], v[236:237]
    v_pk_mul_f32 v[144:145], v[144:145], v[236:237]
    v_cvt_pk_bf16_f32 v170, v138, v139
    v_cvt_pk_bf16_f32 v171, v140, v141
    v_cvt_pk_bf16_f32 v172, v142, v143
    v_cvt_pk_bf16_f32 v173, v144, v145
    ds_write_b128 v248, v[170:173] offset:32768
    s_waitcnt vmcnt(2)
    v_mfma_f32_32x32x16_bf16 v[138:153], v[210:213], v[66:69], 0
    v_add_f32 v162, v162, v163
    v_add_f32 v242, 0x358637bd, v162
    v_rcp_f32 v242, v242
    s_nop 0
    v_mul_f32 v236, v242, v244
    v_mul_f32 v237, v242, v244
    v_pk_mul_f32 v[154:155], v[154:155], v[236:237]
    v_pk_mul_f32 v[156:157], v[156:157], v[236:237]
    v_pk_mul_f32 v[158:159], v[158:159], v[236:237]
    v_pk_mul_f32 v[160:161], v[160:161], v[236:237]
    v_cvt_pk_bf16_f32 v174, v154, v155
    v_cvt_pk_bf16_f32 v175, v156, v157
    v_cvt_pk_bf16_f32 v176, v158, v159
    v_cvt_pk_bf16_f32 v177, v160, v161
    ds_write_b128 v248, v[174:177] offset:33792
    s_waitcnt vmcnt(0)
    v_mfma_f32_32x32x16_bf16 v[154:169], v[214:217], v[70:73], 0
    v_add_f32 v146, v146, v147
    v_add_f32 v242, 0x358637bd, v146
    v_rcp_f32 v242, v242
    s_nop 0
    v_mul_f32 v236, v242, v244
    v_mul_f32 v237, v242, v244
    v_pk_mul_f32 v[138:139], v[138:139], v[236:237]
    v_pk_mul_f32 v[140:141], v[140:141], v[236:237]
    v_pk_mul_f32 v[142:143], v[142:143], v[236:237]
    v_pk_mul_f32 v[144:145], v[144:145], v[236:237]
    v_cvt_pk_bf16_f32 v178, v138, v139
    v_cvt_pk_bf16_f32 v179, v140, v141
    v_cvt_pk_bf16_f32 v180, v142, v143
    v_cvt_pk_bf16_f32 v181, v144, v145
    ds_write_b128 v249, v[178:181] offset:32768
    v_add_f32 v162, v162, v163
    v_add_f32 v242, 0x358637bd, v162
    v_rcp_f32 v242, v242
    s_nop 0
    v_mul_f32 v236, v242, v244
    v_mul_f32 v237, v242, v244
    v_pk_mul_f32 v[154:155], v[154:155], v[236:237]
    v_pk_mul_f32 v[156:157], v[156:157], v[236:237]
    v_pk_mul_f32 v[158:159], v[158:159], v[236:237]
    v_pk_mul_f32 v[160:161], v[160:161], v[236:237]
    v_cvt_pk_bf16_f32 v182, v154, v155
    v_cvt_pk_bf16_f32 v183, v156, v157
    v_cvt_pk_bf16_f32 v184, v158, v159
    v_cvt_pk_bf16_f32 v185, v160, v161
    ds_write_b128 v249, v[182:185] offset:33792
    s_mov_b32 s58, 2
L_FIN:
    s_waitcnt lgkmcnt(0)
    s_barrier
    ds_read2_b32 v[246:247], v246 offset0:0 offset1:16
    ds_read_b128 v[186:189], v250 offset:32768
    ds_read_b128 v[190:193], v250 offset:33024
    ds_read_b128 v[194:197], v250 offset:34816
    ds_read_b128 v[198:201], v250 offset:35072
    ds_read_b128 v[202:205], v250 offset:36864
    ds_read_b128 v[206:209], v250 offset:37120
    s_cmp_lg_u32 s58, 0
    s_cbranch_scc1 yl_30
    s_and_b32 s63, s63, s52
    s_cmp_lg_u32 s63, 32
    s_cbranch_scc1 yl_30
    buffer_load_dwordx4 v[42:45], v1, s[36:39], s12 offen offset:0 sc1
    buffer_load_dwordx4 v[46:49], v1, s[36:39], s12 offen offset:1024 sc1
    buffer_load_dwordx4 v[50:53], v1, s[36:39], s12 offen offset:2048 sc1
    buffer_load_dwordx4 v[54:57], v1, s[36:39], s12 offen offset:3072 sc1
    s_add_u32 s12, s12, 4096
    buffer_load_dwordx4 v[58:61], v1, s[36:39], s12 offen offset:0 sc1
    buffer_load_dwordx4 v[62:65], v1, s[36:39], s12 offen offset:1024 sc1
    buffer_load_dwordx4 v[66:69], v1, s[36:39], s12 offen offset:2048 sc1
    buffer_load_dwordx4 v[70:73], v1, s[36:39], s12 offen offset:3072 sc1
    s_mov_b32 s58, 1
yl_30:
    s_waitcnt lgkmcnt(4)
    v_mfma_f32_16x16x32_bf16 v[154:157], v[74:77], v[186:189], 0
    ds_read_b128 v[210:213], v250 offset:38912
    ds_read_b128 v[214:217], v250 offset:39168
    v_mfma_f32_16x16x32_bf16 v[162:165], v[74:77], v[190:193], 0
    v_mfma_f32_16x16x32_bf16 v[158:161], v[78:81], v[186:189], 0
    v_mfma_f32_16x16x32_bf16 v[166:169], v[78:81], v[190:193], 0
    s_waitcnt lgkmcnt(4)
    v_mfma_f32_16x16x32_bf16 v[154:157], v[82:85], v[194:197], v[154:157]
    ds_read_b128 v[186:189], v250 offset:40960
    ds_read_b128 v[190:193], v250 offset:41216
    v_mfma_f32_16x16x32_bf16 v[162:165], v[82:85], v[198:201], v[162:165]
    v_mfma_f32_16x16x32_bf16 v[158:161], v[86:89], v[194:197], v[158:161]
    v_mfma_f32_16x16x32_bf16 v[166:169], v[86:89], v[198:201], v[166:169]
    s_waitcnt lgkmcnt(4)
    v_mfma_f32_16x16x32_bf16 v[154:157], v[90:93], v[202:205], v[154:157]
    ds_read_b128 v[194:197], v250 offset:43008
    ds_read_b128 v[198:201], v250 offset:43264
    v_mfma_f32_16x16x32_bf16 v[162:165], v[90:93], v[206:209], v[162:165]
    v_mfma_f32_16x16x32_bf16 v[158:161], v[94:97], v[202:205], v[158:161]
    v_mfma_f32_16x16x32_bf16 v[166:169], v[94:97], v[206:209], v[166:169]
    s_waitcnt lgkmcnt(4)
    v_mfma_f32_16x16x32_bf16 v[154:157], v[98:101], v[210:213], v[154:157]
    ds_read_b128 v[202:205], v250 offset:45056
    ds_read_b128 v[206:209], v250 offset:45312
    v_mfma_f32_16x16x32_bf16 v[162:165], v[98:101], v[214:217], v[162:165]
    v_mfma_f32_16x16x32_bf16 v[158:161], v[102:105], v[210:213], v[158:161]
    v_mfma_f32_16x16x32_bf16 v[166:169], v[102:105], v[214:217], v[166:169]
    s_waitcnt lgkmcnt(4)
    v_mfma_f32_16x16x32_bf16 v[154:157], v[106:109], v[186:189], v[154:157]
    ds_read_b128 v[210:213], v250 offset:47104
    ds_read_b128 v[214:217], v250 offset:47360
    v_mfma_f32_16x16x32_bf16 v[162:165], v[106:109], v[190:193], v[162:165]
    v_mfma_f32_16x16x32_bf16 v[158:161], v[110:113], v[186:189], v[158:161]
    v_mfma_f32_16x16x32_bf16 v[166:169], v[110:113], v[190:193], v[166:169]
    s_waitcnt lgkmcnt(4)
    v_mfma_f32_16x16x32_bf16 v[154:157], v[114:117], v[194:197], v[154:157]
    v_mfma_f32_16x16x32_bf16 v[162:165], v[114:117], v[198:201], v[162:165]
    v_mfma_f32_16x16x32_bf16 v[158:161], v[118:121], v[194:197], v[158:161]
    v_mfma_f32_16x16x32_bf16 v[166:169], v[118:121], v[198:201], v[166:169]
    s_cmp_eq_u32 s58, 2
    s_cbranch_scc1 yz_32
    s_cmp_eq_u32 s58, 1
    s_cbranch_scc1 yo_31
    s_mov_b32 s66, 0x2000
p_33:
    s_sub_u32 s66, s66, 1
    s_cbranch_scc1 q_35
    s_mov_b32 s63, 0
    s_atomic_add s63, s[30:31], 65536 glc
    s_mov_b32 s52, 0
    s_atomic_add s52, s[30:31], 65792 glc
c_34:
    s_waitcnt lgkmcnt(0)
    s_and_b32 s63, s63, s52
    s_cmp_lg_u32 s63, 32
    s_cbranch_scc1 p_33
q_35:
    buffer_load_dwordx4 v[42:45], v1, s[36:39], s12 offen offset:0 sc1
    buffer_load_dwordx4 v[46:49], v1, s[36:39], s12 offen offset:1024 sc1
    buffer_load_dwordx4 v[50:53], v1, s[36:39], s12 offen offset:2048 sc1
    buffer_load_dwordx4 v[54:57], v1, s[36:39], s12 offen offset:3072 sc1
    s_add_u32 s12, s12, 4096
    buffer_load_dwordx4 v[58:61], v1, s[36:39], s12 offen offset:0 sc1
    buffer_load_dwordx4 v[62:65], v1, s[36:39], s12 offen offset:1024 sc1
    buffer_load_dwordx4 v[66:69], v1, s[36:39], s12 offen offset:2048 sc1
    buffer_load_dwordx4 v[70:73], v1, s[36:39], s12 offen offset:3072 sc1
yo_31:
    s_waitcnt vmcnt(7)
    ds_write_b128 v248, v[42:45] offset:0
    s_waitcnt vmcnt(6)
    ds_write_b128 v249, v[46:49] offset:512
    s_waitcnt vmcnt(5)
    ds_write_b128 v248, v[50:53] offset:1024
    s_waitcnt vmcnt(4)
    ds_write_b128 v249, v[54:57] offset:1536
    s_waitcnt vmcnt(3)
    ds_write_b128 v248, v[58:61] offset:2048
    s_waitcnt vmcnt(2)
    ds_write_b128 v249, v[62:65] offset:2560
    s_waitcnt vmcnt(1)
    ds_write_b128 v248, v[66:69] offset:3072
    s_waitcnt vmcnt(0)
    ds_write_b128 v249, v[70:73] offset:3584
yz_32:
    s_waitcnt lgkmcnt(0)
    s_barrier
    ds_read_b64_tr_b16 v[74:75], v234 offset:0
    ds_read_b64_tr_b16 v[76:77], v234 offset:256
    ds_read_b64_tr_b16 v[78:79], v235 offset:0
    ds_read_b64_tr_b16 v[80:81], v235 offset:256
    ds_read_b64_tr_b16 v[82:83], v234 offset:2048
    ds_read_b64_tr_b16 v[84:85], v234 offset:2304
    ds_read_b64_tr_b16 v[86:87], v235 offset:2048
    ds_read_b64_tr_b16 v[88:89], v235 offset:2304
    ds_read_b64_tr_b16 v[90:91], v234 offset:4096
    ds_read_b64_tr_b16 v[92:93], v234 offset:4352
    ds_read_b64_tr_b16 v[94:95], v235 offset:4096
    ds_read_b64_tr_b16 v[96:97], v235 offset:4352
    v_mfma_f32_16x16x32_bf16 v[154:157], v[122:125], v[202:205], v[154:157]
    v_mfma_f32_16x16x32_bf16 v[162:165], v[122:125], v[206:209], v[162:165]
    v_mfma_f32_16x16x32_bf16 v[158:161], v[126:129], v[202:205], v[158:161]
    v_mfma_f32_16x16x32_bf16 v[166:169], v[126:129], v[206:209], v[166:169]
    v_mfma_f32_16x16x32_bf16 v[154:157], v[130:133], v[210:213], v[154:157]
    v_mfma_f32_16x16x32_bf16 v[162:165], v[130:133], v[214:217], v[162:165]
    v_mfma_f32_16x16x32_bf16 v[158:161], v[134:137], v[210:213], v[158:161]
    v_mfma_f32_16x16x32_bf16 v[166:169], v[134:137], v[214:217], v[166:169]
    s_lshl_b32 s50, s65, 31
    v_mul_f32 v246, 0x36000000, v246
    v_xor_b32 v236, s50, v246
    v_mul_f32 v247, 0x36000000, v247
    v_xor_b32 v237, s50, v247
    s_waitcnt lgkmcnt(8)
    v_mfma_f32_16x16x32_bf16 v[138:141], v[10:13], v[74:77], 0
    v_mfma_f32_16x16x32_bf16 v[142:145], v[10:13], v[78:81], 0
    ds_read_b64_tr_b16 v[98:99], v234 offset:6144
    ds_read_b64_tr_b16 v[100:101], v234 offset:6400
    ds_read_b64_tr_b16 v[102:103], v235 offset:6144
    ds_read_b64_tr_b16 v[104:105], v235 offset:6400
    s_waitcnt lgkmcnt(8)
    v_mfma_f32_16x16x32_bf16 v[138:141], v[14:17], v[82:85], v[138:141]
    v_mfma_f32_16x16x32_bf16 v[142:145], v[14:17], v[86:89], v[142:145]
    ds_read_b64_tr_b16 v[106:107], v234 offset:8192
    ds_read_b64_tr_b16 v[108:109], v234 offset:8448
    ds_read_b64_tr_b16 v[110:111], v235 offset:8192
    ds_read_b64_tr_b16 v[112:113], v235 offset:8448
    s_waitcnt lgkmcnt(8)
    v_mfma_f32_16x16x32_bf16 v[138:141], v[18:21], v[90:93], v[138:141]
    v_mfma_f32_16x16x32_bf16 v[142:145], v[18:21], v[94:97], v[142:145]
    ds_read_b64_tr_b16 v[114:115], v234 offset:10240
    ds_read_b64_tr_b16 v[116:117], v234 offset:10496
    ds_read_b64_tr_b16 v[118:119], v235 offset:10240
    ds_read_b64_tr_b16 v[120:121], v235 offset:10496
    s_waitcnt lgkmcnt(8)
    v_mfma_f32_16x16x32_bf16 v[138:141], v[22:25], v[98:101], v[138:141]
    v_mfma_f32_16x16x32_bf16 v[142:145], v[22:25], v[102:105], v[142:145]
    ds_read_b64_tr_b16 v[122:123], v234 offset:12288
    ds_read_b64_tr_b16 v[124:125], v234 offset:12544
    ds_read_b64_tr_b16 v[126:127], v235 offset:12288
    ds_read_b64_tr_b16 v[128:129], v235 offset:12544
    s_waitcnt lgkmcnt(8)
    v_mfma_f32_16x16x32_bf16 v[138:141], v[26:29], v[106:109], v[138:141]
    v_mfma_f32_16x16x32_bf16 v[142:145], v[26:29], v[110:113], v[142:145]
    ds_read_b64_tr_b16 v[130:131], v234 offset:14336
    ds_read_b64_tr_b16 v[132:133], v234 offset:14592
    ds_read_b64_tr_b16 v[134:135], v235 offset:14336
    ds_read_b64_tr_b16 v[136:137], v235 offset:14592
    s_waitcnt lgkmcnt(8)
    v_mfma_f32_16x16x32_bf16 v[138:141], v[30:33], v[114:117], v[138:141]
    v_mfma_f32_16x16x32_bf16 v[142:145], v[30:33], v[118:121], v[142:145]
    s_waitcnt lgkmcnt(4)
    v_mfma_f32_16x16x32_bf16 v[138:141], v[34:37], v[122:125], v[138:141]
    v_mfma_f32_16x16x32_bf16 v[142:145], v[34:37], v[126:129], v[142:145]
    s_waitcnt lgkmcnt(0)
    v_mfma_f32_16x16x32_bf16 v[138:141], v[38:41], v[130:133], v[138:141]
    v_mfma_f32_16x16x32_bf16 v[142:145], v[38:41], v[134:137], v[142:145]
    s_nop 6
    v_fmac_f32 v154, v246, v138
    v_fmac_f32 v155, v246, v139
    v_fmac_f32 v156, v246, v140
    v_fmac_f32 v157, v246, v141
    ds_write_b128 v251, v[154:157] offset:0
    v_fmac_f32 v158, v236, v138
    v_fmac_f32 v159, v236, v139
    v_fmac_f32 v160, v236, v140
    v_fmac_f32 v161, v236, v141
    ds_write_b128 v251, v[158:161] offset:256
    v_fmac_f32 v162, v247, v142
    v_fmac_f32 v163, v247, v143
    v_fmac_f32 v164, v247, v144
    v_fmac_f32 v165, v247, v145
    ds_write_b128 v251, v[162:165] offset:8448
    v_fmac_f32 v166, v237, v142
    v_fmac_f32 v167, v237, v143
    v_fmac_f32 v168, v237, v144
    v_fmac_f32 v169, v237, v145
    ds_write_b128 v251, v[166:169] offset:8704
    s_waitcnt lgkmcnt(0)
    s_barrier
    ds_read_b128 v[42:45], v255 offset:0
    ds_read_b128 v[50:53], v255 offset:16896
    ds_read_b128 v[46:49], v255 offset:16
    ds_read_b128 v[54:57], v255 offset:16912
    s_waitcnt lgkmcnt(2)
    v_pk_add_f32 v[42:43], v[50:51], v[42:43]
    v_pk_add_f32 v[44:45], v[52:53], v[44:45]
    v_cvt_pk_bf16_f32 v138, v42, v43
    v_cvt_pk_bf16_f32 v139, v44, v45
    s_waitcnt lgkmcnt(0)
    v_pk_add_f32 v[46:47], v[54:55], v[46:47]
    v_pk_add_f32 v[48:49], v[56:57], v[48:49]
    v_cvt_pk_bf16_f32 v140, v46, v47
    v_cvt_pk_bf16_f32 v141, v48, v49
    buffer_store_dwordx4 v[138:141], v252, s[32:35], s15 offen nt
L_end:
L_done:
    s_endpgm
L_sp5:
    s_mov_b32 s38, 9437184
    s_mov_b32 s39, 0x20000
    v_lshlrev_b32 v6, 8, v0
    s_mul_i32 s3, s40, 12288
    s_add_u32 s3, s3, 8978432
    s_mov_b32 exec_hi, 0xffff
    buffer_store_dword v4, v6, s[36:39], s3 offen sc1
    s_mov_b32 exec_hi, -1
    s_branch L_sp5r
L_sp6:
    s_mov_b32 s3, 1
    s_atomic_add s3, s[100:101], 0
    s_branch L_sp6r
L_sp4:
    s_mov_b32 s8, 0
    s_atomic_add s8, s[28:29], 0 glc
    s_mov_b32 s9, 0
    s_atomic_add s9, s[28:29], 256 glc
    s_mov_b32 s10, 0
    s_atomic_add s10, s[28:29], 512 glc
    s_mov_b32 s11, 0
    s_atomic_add s11, s[28:29], 768 glc
    s_mov_b32 s12, 0
    s_atomic_add s12, s[28:29], 1024 glc
    s_mov_b32 s13, 0
    s_atomic_add s13, s[28:29], 1280 glc
    s_mov_b32 s14, 0
    s_atomic_add s14, s[28:29], 1536 glc
    s_mov_b32 s15, 0
    s_atomic_add s15, s[28:29], 1792 glc
    s_branch L_sp4r
L_sp3:
    s_mov_b32 s57, 0x2000
    s_branch L_sp3c
L_sp3p:
    s_sub_u32 s57, s57, 1
    s_cbranch_scc1 L_sp3q
    s_mov_b32 s8, 0
    s_atomic_add s8, s[28:29], 0 glc
    s_mov_b32 s9, 0
    s_atomic_add s9, s[28:29], 256 glc
    s_mov_b32 s10, 0
    s_atomic_add s10, s[28:29], 512 glc
    s_mov_b32 s11, 0
    s_atomic_add s11, s[28:29], 768 glc
    s_mov_b32 s12, 0
    s_atomic_add s12, s[28:29], 1024 glc
    s_mov_b32 s13, 0
    s_atomic_add s13, s[28:29], 1280 glc
    s_mov_b32 s14, 0
    s_atomic_add s14, s[28:29], 1536 glc
    s_mov_b32 s15, 0
    s_atomic_add s15, s[28:29], 1792 glc
L_sp3c:
    s_waitcnt lgkmcnt(0)
    s_and_b32 s8, s8, s9
    s_and_b32 s8, s8, s10
    s_and_b32 s8, s8, s11
    s_and_b32 s8, s8, s12
    s_and_b32 s8, s8, s13
    s_and_b32 s8, s8, s14
    s_and_b32 s8, s8, s15
    s_cmp_lg_u32 s8, 32
    s_cbranch_scc1 L_sp3p
L_sp3q:
    s_add_u32 s56, s62, 9109504
    buffer_load_dwordx4 v[154:157], v1, s[36:39], s56 offen sc1
    buffer_load_dwordx4 v[158:161], v1, s[36:39], s56 offen offset:1024 sc1
    s_add_u32 s6, s6, 4
    s_addc_u32 s7, s7, 0
    s_setpc_b64 s[6:7]
L_sp2:
    v_lshrrev_b32 v10, 4, v0
    s_lshl_b32 s50, s47, 4
    v_lshl_add_u32 v10, v10, 8, v17
    v_add_u32 v10, s50, v10
    v_sub_u32 v11, 831, v10
    s_mov_b32 s50, 133888
    v_lshl_add_u32 v11, v11, 2, s50
    v_subrev_u32 v10, 1, v10
    v_and_b32 v138, 2047, v10
    v_lshl_add_u32 v10, v10, 2, s50
    v_lshl_add_u32 v138, v138, 2, s50
    v_cvt_pk_bf16_f32 v130, v90, v98
    v_cvt_pk_bf16_f32 v131, v91, v99
    v_cvt_pk_bf16_f32 v132, v92, v100
    v_cvt_pk_bf16_f32 v133, v93, v101
    v_cvt_pk_bf16_f32 v134, v94, v102
    v_cvt_pk_bf16_f32 v135, v95, v103
    v_cvt_pk_bf16_f32 v136, v96, v104
    v_cvt_pk_bf16_f32 v137, v97, v105
    ds_write_b32 v138, v130
    ds_write_b32 v10, v131 offset:256
    ds_write2st64_b32 v10, v132, v133 offset0:2 offset1:3
    ds_write2st64_b32 v10, v134, v135 offset0:16 offset1:17
    ds_write2st64_b32 v10, v136, v137 offset0:18 offset1:19
    v_mov_b32 v8, 6
    ds_write_b32 v2, v8
    ds_read_b128 v[4:7], v3 offset:0
    v_lshlrev_b32 v114, 16, v154
    v_and_b32 v122, 0xffff0000, v154
    v_lshlrev_b32 v115, 16, v155
    v_and_b32 v123, 0xffff0000, v155
    v_lshlrev_b32 v116, 16, v156
    v_and_b32 v124, 0xffff0000, v156
    v_lshlrev_b32 v117, 16, v157
    v_and_b32 v125, 0xffff0000, v157
    v_lshlrev_b32 v118, 16, v158
    v_and_b32 v126, 0xffff0000, v158
    v_lshlrev_b32 v119, 16, v159
    v_and_b32 v127, 0xffff0000, v159
    v_lshlrev_b32 v120, 16, v160
    v_and_b32 v128, 0xffff0000, v160
    v_lshlrev_b32 v121, 16, v161
    v_and_b32 v129, 0xffff0000, v161
sw_36:
    s_waitcnt lgkmcnt(0)
    v_min3_u32 v4, v4, v5, v6
    v_min_u32 v4, v4, v7
    s_nop 0
    v_readfirstlane_b32 s57, v4
    s_nop 1
    s_cmp_ge_u32 s57, 6
    s_cbranch_scc1 sd_37
    ds_read_b128 v[4:7], v3 offset:0
    s_branch sw_36
sd_37:
    ds_read2st64_b32 v[130:131], v11 offset0:19 offset1:18
    ds_read2st64_b32 v[132:133], v11 offset0:17 offset1:16
    ds_read2st64_b32 v[134:135], v11 offset0:3 offset1:2
    ds_read2st64_b32 v[136:137], v11 offset0:1 offset1:0
    v_lshlrev_b32 v146, 16, v240
    v_and_b32 v154, 0xffff0000, v240
    v_lshlrev_b32 v147, 16, v241
    v_and_b32 v155, 0xffff0000, v241
    v_lshlrev_b32 v148, 16, v242
    v_and_b32 v156, 0xffff0000, v242
    v_lshlrev_b32 v149, 16, v243
    v_and_b32 v157, 0xffff0000, v243
    v_lshlrev_b32 v150, 16, v244
    v_and_b32 v158, 0xffff0000, v244
    v_lshlrev_b32 v151, 16, v245
    v_and_b32 v159, 0xffff0000, v245
    v_lshlrev_b32 v152, 16, v246
    v_and_b32 v160, 0xffff0000, v246
    v_lshlrev_b32 v153, 16, v247
    v_and_b32 v161, 0xffff0000, v247
    v_pk_mul_f32 v[178:179], v[90:91], v[146:147]
    v_pk_mul_f32 v[186:187], v[90:91], v[154:155]
    v_pk_mul_f32 v[180:181], v[92:93], v[148:149]
    v_pk_mul_f32 v[188:189], v[92:93], v[156:157]
    v_pk_mul_f32 v[182:183], v[94:95], v[150:151]
    v_pk_mul_f32 v[190:191], v[94:95], v[158:159]
    v_pk_mul_f32 v[184:185], v[96:97], v[152:153]
    v_pk_mul_f32 v[192:193], v[96:97], v[160:161]
    v_pk_fma_f32 v[178:179], v[98:99], v[154:155], v[178:179] neg_lo:[1,0,0] neg_hi:[1,0,0]
    v_pk_fma_f32 v[186:187], v[98:99], v[146:147], v[186:187]
    v_pk_fma_f32 v[180:181], v[100:101], v[156:157], v[180:181] neg_lo:[1,0,0] neg_hi:[1,0,0]
    v_pk_fma_f32 v[188:189], v[100:101], v[148:149], v[188:189]
    v_pk_fma_f32 v[182:183], v[102:103], v[158:159], v[182:183] neg_lo:[1,0,0] neg_hi:[1,0,0]
    v_pk_fma_f32 v[190:191], v[102:103], v[150:151], v[190:191]
    v_pk_fma_f32 v[184:185], v[104:105], v[160:161], v[184:185] neg_lo:[1,0,0] neg_hi:[1,0,0]
    v_pk_fma_f32 v[192:193], v[104:105], v[152:153], v[192:193]
    s_waitcnt lgkmcnt(0)
    v_lshlrev_b32 v162, 16, v130
    v_and_b32 v170, 0xffff0000, v130
    v_lshlrev_b32 v163, 16, v131
    v_and_b32 v171, 0xffff0000, v131
    v_lshlrev_b32 v164, 16, v132
    v_and_b32 v172, 0xffff0000, v132
    v_lshlrev_b32 v165, 16, v133
    v_and_b32 v173, 0xffff0000, v133
    v_lshlrev_b32 v166, 16, v134
    v_and_b32 v174, 0xffff0000, v134
    v_lshlrev_b32 v167, 16, v135
    v_and_b32 v175, 0xffff0000, v135
    v_lshlrev_b32 v168, 16, v136
    v_and_b32 v176, 0xffff0000, v136
    v_lshlrev_b32 v169, 16, v137
    v_and_b32 v177, 0xffff0000, v137
    v_pk_fma_f32 v[178:179], v[162:163], v[114:115], v[178:179]
    v_pk_fma_f32 v[186:187], v[162:163], v[122:123], v[186:187]
    v_pk_fma_f32 v[180:181], v[164:165], v[116:117], v[180:181]
    v_pk_fma_f32 v[188:189], v[164:165], v[124:125], v[188:189]
    v_pk_fma_f32 v[182:183], v[166:167], v[118:119], v[182:183]
    v_pk_fma_f32 v[190:191], v[166:167], v[126:127], v[190:191]
    v_pk_fma_f32 v[184:185], v[168:169], v[120:121], v[184:185]
    v_pk_fma_f32 v[192:193], v[168:169], v[128:129], v[192:193]
    v_pk_fma_f32 v[178:179], v[170:171], v[122:123], v[178:179]
    v_pk_fma_f32 v[186:187], v[170:171], v[114:115], v[186:187] neg_lo:[1,0,0] neg_hi:[1,0,0]
    v_pk_fma_f32 v[180:181], v[172:173], v[124:125], v[180:181]
    v_pk_fma_f32 v[188:189], v[172:173], v[116:117], v[188:189] neg_lo:[1,0,0] neg_hi:[1,0,0]
    v_pk_fma_f32 v[182:183], v[174:175], v[126:127], v[182:183]
    v_pk_fma_f32 v[190:191], v[174:175], v[118:119], v[190:191] neg_lo:[1,0,0] neg_hi:[1,0,0]
    v_pk_fma_f32 v[184:185], v[176:177], v[128:129], v[184:185]
    v_pk_fma_f32 v[192:193], v[176:177], v[120:121], v[192:193] neg_lo:[1,0,0] neg_hi:[1,0,0]
    v_cvt_pk_bf16_f32 v82, v178, v179
    v_cvt_pk_bf16_f32 v83, v180, v181
    v_cvt_pk_bf16_f32 v84, -v186, -v187
    v_cvt_pk_bf16_f32 v85, -v188, -v189
    v_cvt_pk_bf16_f32 v86, v182, v183
    v_cvt_pk_bf16_f32 v87, v184, v185
    v_cvt_pk_bf16_f32 v88, -v190, -v191
    v_cvt_pk_bf16_f32 v89, -v192, -v193
    s_nop 1
    s_branch L_sp2r
.p2align 8
.fill (33792 - (. - gated_mix__spectral_gfnet__linear_attn_block__prompt_kernel)) / 4, 4, 0xbf800000
.section .rodata,"a"
.p2align 6
.amdhsa_kernel gated_mix__spectral_gfnet__linear_attn_block__prompt_kernel
  .amdhsa_next_free_vgpr 256
  .amdhsa_next_free_sgpr 102
  .amdhsa_accum_offset 256
  .amdhsa_group_segment_fixed_size 0
  .amdhsa_kernarg_size 80
  .amdhsa_user_sgpr_count 2
  .amdhsa_user_sgpr_kernarg_segment_ptr 1
  .amdhsa_system_sgpr_workgroup_id_x 1
  .amdhsa_float_denorm_mode_32 3
  .amdhsa_float_denorm_mode_16_64 3
.end_amdhsa_kernel
```
